```python
import torch

def _softmax(x, axis=-1):
    return torch.softmax(x, dim=axis)
def _gelu(x):
    return torch.nn.functional.gelu(x, approximate="tanh")
def _silu(x):
    return torch.nn.functional.silu(x)
def _sigmoid(x):
    return torch.sigmoid(x)
def _layernorm(x, axis=-1, eps=1e-5):
    m = x.mean(dim=axis, keepdim=True)
    v = x.var(dim=axis, keepdim=True, unbiased=False)
    return (x - m) / torch.sqrt(v + eps)
def _scatter_add(tgt, idx, src, axis=0):
    return tgt.clone().index_add_(axis, idx, src)
def _segment_sum(src, seg, n):
    out = torch.zeros((n,) + src.shape[1:], dtype=src.dtype)
    return out.index_add_(0, seg, src)
def _pad(x, pw):
    flat = tuple(v for pair in reversed(pw) for v in pair)
    return torch.nn.functional.pad(x, flat)

kernel_name = 'parallel_sum__sliding_local_dilated__dense_activation_relu__prompt'

def setup_inputs():

    _w = (lambda a: (lambda t: t.to(torch.bfloat16) if t.is_floating_point() else t)(torch.as_tensor(a)))
    def _A_setup():
        B, S, D = 1, 2048, 640
        return {
            "x": _w((lambda *s: torch.randn(*s, dtype=torch.bfloat16) * 0.05)(B, S, D)),
            "wqkv": _w((lambda *s: torch.randn(*s, dtype=torch.bfloat16) * 0.05)(D, 3 * D)),
            "wo": _w((lambda *s: torch.randn(*s, dtype=torch.bfloat16) * 0.05)(D, D)),
        }
    _A_in = _A_setup()

    def _B_setup():
        B, S, D, Dff = 1, 2048, 640, 1536
        return {
            "x": _w((lambda *s: torch.randn(*s, dtype=torch.bfloat16) * 0.05)(B, S, D)),
            "w1": _w((lambda *s: torch.randn(*s, dtype=torch.bfloat16) * 0.05)(D, Dff)),
            "w2": _w((lambda *s: torch.randn(*s, dtype=torch.bfloat16) * 0.05)(Dff, D)),
        }
    _B_in = _B_setup()

    return {
        "A_x": _A_in["x"],
        "A_wqkv": _A_in["wqkv"],
        "A_wo": _A_in["wo"],
        "B_x": _B_in["x"],
        "B_w1": _B_in["w1"],
        "B_w2": _B_in["w2"],
    }

def reference(A_x, A_wqkv, A_wo, B_x, B_w1, B_w2):
    def _A_ref(x, wqkv, wo):
        B, S, D = x.shape
        H = 32; Dh = D // H
        W, dil = 8, 2
        qkv = (lambda x, *d: x.permute(*d))((x @ wqkv).reshape(B, S, 3, H, Dh), 2, 0, 3, 1, 4)
        q, k, v = qkv[0], qkv[1], qkv[2]
        scale = Dh ** -0.5
        pos = torch.arange(S)
        off = torch.arange(W) * dil
        idx = pos[:, None] - off[None, :]
        mask = idx >= 0
        idx_c = torch.where(mask, idx, 0).reshape(-1)
        kg = k[:, :, idx_c, :].reshape(B, H, S, W, Dh)
        vg = v[:, :, idx_c, :].reshape(B, H, S, W, Dh)
        logits = torch.einsum("bhsd,bhswd->bhsw", q, kg) * scale
        logits = torch.where(mask[None, None, :, :], logits, -1e9)
        attn = _softmax(logits, axis=-1)
        o = torch.einsum("bhsw,bhswd->bhsd", attn, vg)
        return (lambda x, *d: x.permute(*d))(o, 0, 2, 1, 3).reshape(B, S, D) @ wo

    def _B_ref(x, w1, w2):
        h = torch.einsum("bsd,df->bsf", x, w1)
        zero = torch.zeros_like(h)
        h = torch.maximum(h, zero)
        return torch.einsum("bsf,fd->bsd", h, w2)

    x = A_x
    xn = _layernorm(x, axis=-1)
    return x + _A_ref(xn, A_wqkv, A_wo) + _B_ref(xn, B_w1, B_w2)
```

```asm
; @launch grid=(256,1,1) block=(256,1,1) lds=163840
.amdgcn_target "amdgcn-amd-amdhsa--gfx950"
.text
.globl parallel_sum__sliding_local_dilated__dense_activation_relu__prompt_kernel
.p2align 8
.type parallel_sum__sliding_local_dilated__dense_activation_relu__prompt_kernel,@function
parallel_sum__sliding_local_dilated__dense_activation_relu__prompt_kernel:
    s_cmp_ge_u32 s2, 256
    s_cbranch_scc1 L_end
    s_getpc_b64 s[56:57]
L_pc:
    s_load_dwordx2 s[4:5], s[0:1], 0
    s_load_dwordx2 s[16:17], s[0:1], 32
    s_load_dwordx2 s[8:9], s[0:1], 8
    s_load_dwordx2 s[28:29], s[0:1], 64
    s_load_dwordx2 s[12:13], s[0:1], 16
    s_load_dwordx2 s[20:21], s[0:1], 40
    s_load_dwordx2 s[24:25], s[0:1], 48
    s_lshr_b32 s55, s2, 3
    s_lshl_b32 s59, s55, 4
    v_lshrrev_b32 v136, 6, v0
    v_and_b32 v137, 3, v0
    v_lshl_add_u32 v137, v136, 2, v137
    v_add_lshl_u32 v137, s59, v137, 7
    v_min_u32 v137, L_last-L_pc-4, v137
    v_mov_b32 v139, s57
    v_add_co_u32 v138, vcc, s56, v137
    v_readfirstlane_b32 s32, v136
    v_and_b32 v1, 63, v0
    v_addc_co_u32 v139, vcc, 0, v139, vcc
    global_load_dword v255, v[138:139], off
    s_and_b32 s58, s2, 7
    s_lshr_b32 s59, s58, 1
    s_and_b32 s58, s58, 1
    s_and_b32 s33, s55, 3
    s_lshl2_add_u32 s33, s59, s33
    v_lshrrev_b32 v140, 3, v1
    v_lshrrev_b32 v141, 4, v1
    v_and_b32 v142, 7, v1
    v_xor_b32 v142, v142, v141
    v_lshlrev_b32 v142, 4, v142
    v_mul_u32_u24 v4, 0xa00, v140
    v_add_u32 v4, v4, v142
    v_xor_b32 v28, 64, v4
    v_add_u32 v5, 0x100, v4
    v_add_u32 v29, 0x4900, v28
    v_add_u32 v28, 0x4800, v28
    s_lshr_b32 s90, s55, 2
    s_add_u32 s90, s90, s55
    s_and_b32 s90, s90, 3
    s_mul_i32 s90, s90, 5
    s_lshr_b32 s90, s90, 1
    s_mov_b32 s85, s90
    s_lshl2_add_u32 s38, s33, s32
    s_mul_i32 s38, s38, 0xa000
    s_lshl_b32 s86, s85, 7
    s_add_u32 s86, s86, s38
    s_lshl_b32 s39, s32, 14
    s_add_u32 s39, s39, 0x5000
    s_mov_b32 s6, 0x280000
    s_mov_b32 s7, 0x20000
    s_waitcnt lgkmcnt(0)
    s_add_u32 m0, s39, 0
    s_nop 0
    buffer_load_dwordx4 v4, s[4:7], s86 offen lds
    buffer_load_dwordx4 v5, s[4:7], s86 offen offset:1024 lds
    buffer_load_dwordx4 v28, s[4:7], s86 offen offset:2048 lds
    buffer_load_dwordx4 v29, s[4:7], s86 offen offset:3072 lds
    s_mov_b32 s18, 0x1e0000
    s_mov_b32 s19, 0x20000
    s_lshr_b32 s34, s55, 2
    s_lshl3_add_u32 s34, s58, s34
    s_mul_i32 s87, s32, 0xc000
    s_mul_i32 s56, s34, 0xc0
    s_add_u32 s87, s87, s56
    s_mul_i32 s40, s85, 0x30000
    s_add_u32 s40, s40, s87
    s_mul_i32 s41, s32, 0xc00
    s_add_u32 s41, s41, 0x15000
    s_mov_b32 s30, 0x1000000
    s_mov_b32 s31, 0x20000
    v_mov_b32 v143, 0
    v_mov_b32 v150, 0x7ffffff0
    s_lshl2_add_u32 s56, s34, s32
    s_lshl_b32 s56, s56, 1
    s_lshl_b32 s57, s33, 7
    s_add_u32 s56, s56, s57
    v_lshrrev_b32 v233, 5, v1
    v_add_u32 v233, s56, v233
    v_and_b32 v144, 31, v1
    v_cmp_gt_u32 vcc, 16, v144
    v_mul_u32_u24 v232, 0x500, v233
    v_lshl_add_u32 v232, v144, 4, v232
    v_cndmask_b32 v234, v150, v232, vcc
    s_lshl_b32 s56, s2, 7
    s_add_u32 s56, s56, 0x1000
    v_cmp_eq_u32 vcc, 1, v0
    v_mov_b32 v235, s56
    s_nop 0
    v_cndmask_b32 v235, 0, v235, vcc
    s_waitcnt lgkmcnt(0)
    v_add_u32 v144, 0, v1
    v_mul_u32_u24 v145, 0xab, v144
    v_lshrrev_b32 v145, 11, v145
    v_mul_u32_u24 v146, 12, v145
    v_sub_u32 v144, v144, v146
    v_lshrrev_b32 v146, 2, v145
    v_and_b32 v146, 2, v146
    v_xor_b32 v144, v144, v146
    v_mul_u32_u24 v145, 0xc00, v145
    v_lshl_add_u32 v8, v144, 4, v145
    v_add_u32 v144, 64, v1
    v_mul_u32_u24 v145, 0xab, v144
    v_lshrrev_b32 v145, 11, v145
    v_mul_u32_u24 v146, 12, v145
    v_sub_u32 v144, v144, v146
    v_lshrrev_b32 v146, 2, v145
    v_and_b32 v146, 2, v146
    v_xor_b32 v144, v144, v146
    v_mul_u32_u24 v145, 0xc00, v145
    v_lshl_add_u32 v9, v144, 4, v145
    v_subrev_u32 v9, 0x400, v9
    v_add_u32 v144, 0x80, v1
    v_mul_u32_u24 v145, 0xab, v144
    v_lshrrev_b32 v145, 11, v145
    v_mul_u32_u24 v146, 12, v145
    v_sub_u32 v144, v144, v146
    v_lshrrev_b32 v146, 2, v145
    v_and_b32 v146, 2, v146
    v_xor_b32 v144, v144, v146
    v_mul_u32_u24 v145, 0xc00, v145
    v_lshl_add_u32 v10, v144, 4, v145
    v_subrev_u32 v10, 0x800, v10
    s_add_u32 m0, s41, 0
    s_nop 0
    buffer_load_dwordx4 v8, s[16:19], s40 offen lds
    s_and_b32 s35, s55, 7
    s_lshl3_add_u32 s35, s59, s35
    s_lshr_b32 s36, s55, 3
    s_lshl2_add_u32 s36, s58, s36
    s_mov_b32 s10, 0x258000
    s_mov_b32 s11, 0x20000
    s_mov_b32 s14, 0xc8000
    s_mov_b32 s15, 0x20000
    s_mov_b32 s22, 0x1e0000
    s_mov_b32 s23, 0x20000
    s_mov_b32 s26, 0x280000
    s_mov_b32 s27, 0x20000
    buffer_load_dwordx4 v9, s[16:19], s40 offen offset:1024 lds
    buffer_load_dwordx4 v10, s[16:19], s40 offen offset:2048 lds
    s_add_u32 s85, s85, 1
    s_cmp_eq_u32 s85, 10
    s_cselect_b32 s85, 0, s85
    s_lshl_b32 s86, s85, 7
    s_add_u32 s86, s86, s38
    s_mul_i32 s40, s85, 0x30000
    s_add_u32 s40, s40, s87
    buffer_load_dwordx4 v[236:239], v232, s[4:7], 0 offen
    buffer_load_dwordx4 v[240:243], v232, s[4:7], 0 offen offset:512
    buffer_load_dwordx4 v[244:247], v234, s[4:7], 0 offen offset:1024
    buffer_load_dword v27, v235, s[28:31], 0 offen sc1
    s_mul_i32 s61, s2, 0xab
    s_lshr_b32 s61, s61, 9
    s_mul_i32 s62, s61, 3
    s_sub_u32 s62, s2, s62
    s_mul_i32 s97, s61, 0x7800
    s_mul_i32 s57, s62, 0x500
    s_add_u32 s97, s97, s57
    s_lshl_b32 s57, s32, 6
    v_add_u32 v144, s57, v1
    v_mul_u32_u24 v145, 0xcd, v144
    v_lshrrev_b32 v145, 14, v145
    v_mul_u32_u24 v145, 0xa00, v145
    v_lshl_add_u32 v229, v144, 4, v145
    s_lshl_b32 s60, s32, 10
    s_add_u32 m0, s60, 0x21000
    s_nop 0
    buffer_load_dwordx4 v229, s[8:11], s97 offen nt lds
    v_add_u32 v144, s57, v1
    v_add_u32 v144, 0x100, v144
    v_mul_u32_u24 v145, 0xcd, v144
    v_lshrrev_b32 v145, 14, v145
    v_mul_u32_u24 v145, 0xa00, v145
    v_lshl_add_u32 v230, v144, 4, v145
    s_lshl_b32 s60, s32, 10
    s_add_u32 m0, s60, 0x22000
    s_nop 0
    buffer_load_dwordx4 v230, s[8:11], s97 offen nt lds
    v_add_u32 v144, s57, v1
    v_add_u32 v144, 0x200, v144
    v_mul_u32_u24 v145, 0xcd, v144
    v_lshrrev_b32 v145, 14, v145
    v_cmp_gt_u32 vcc, 0x280, v144
    v_mul_u32_u24 v145, 0xa00, v145
    v_lshl_add_u32 v231, v144, 4, v145
    v_cndmask_b32 v231, v150, v231, vcc
    s_lshl_b32 s60, s32, 10
    s_add_u32 m0, s60, 0x23000
    s_nop 0
    buffer_load_dwordx4 v231, s[8:11], s97 offen nt lds
    v_and_b32 v151, 15, v1
    v_bfe_u32 v153, v1, 2, 2
    v_and_b32 v154, 3, v1
    s_and_b32 s56, s32, 1
    s_lshl_b32 s57, s56, 3
    v_lshrrev_b32 v152, 3, v1
    v_add_u32 v152, s57, v152
    s_lshl_b32 s57, s33, 7
    s_sub_u32 s57, s57, 16
    v_add_u32 v168, s57, v152
    v_cmp_le_i32 vcc, 0, v168
    v_lshrrev_b32 v144, 1, v152
    v_xor_b32 v144, v144, v1
    v_and_b32 v144, 7, v144
    v_mul_u32_u24 v168, 0x500, v168
    v_lshl_add_u32 v168, v144, 4, v168
    v_cndmask_b32 v168, v150, v168, vcc
    v_cmp_lt_u32 vcc, 1, v152
    s_add_u32 m0, s39, 0x1000
    s_nop 0
    buffer_load_dwordx4 v4, s[4:7], s86 offen lds
    v_cndmask_b32 v168, v150, v168, vcc
    s_lshr_b32 s57, s32, 1
    s_mul_i32 s57, s57, 5
    s_lshl_b32 s95, s57, 11
    s_lshl_b32 s56, s56, 10
    s_add_u32 s95, s95, s56
    s_add_u32 s94, s57, s90
    v_lshlrev_b32 v2, 4, v1
    v_add_u32 v3, 0x1000, v2
    v_lshrrev_b32 v144, 1, v151
    v_xor_b32 v144, v144, v141
    v_lshlrev_b32 v144, 4, v144
    v_lshl_add_u32 v17, v151, 7, v144
    v_xor_b32 v18, 64, v17
    v_and_b32 v144, 8, v151
    v_lshlrev_b32 v144, 7, v144
    v_add3_u32 v6, s39, v17, v144
    v_xor_b32 v7, 64, v6
    buffer_load_dwordx4 v5, s[4:7], s86 offen offset:1024 lds
    v_lshl_add_u32 v144, v141, 3, v153
    v_mul_u32_u24 v144, 0xc0, v144
    v_lshl_add_u32 v144, v154, 3, v144
    v_and_b32 v145, 1, v141
    v_lshl_add_u32 v144, v145, 5, v144
    s_cmp_eq_u32 s32, 3
    s_cselect_b32 s68, 0, s32
    s_lshl_b32 s56, s33, 1
    s_lshr_b32 s57, s32, 1
    s_add_u32 s67, s56, s57
    s_mul_i32 s43, s67, 0x44000
    s_and_b32 s57, s32, 1
    s_lshl_b32 s57, s57, 11
    s_add_u32 s43, s43, s57
    s_add_u32 s43, s43, 0x540000
    s_add_u32 s56, s68, 0
    s_cmp_ge_u32 s56, 3
    s_cselect_b32 s57, 3, 0
    s_sub_u32 s56, s56, s57
    s_lshl_b32 s57, s56, 6
    buffer_load_dwordx4 v28, s[4:7], s86 offen offset:2048 lds
    s_add_u32 s57, s57, 0x15000
    v_add_u32 v11, s57, v144
    v_xor_b32 v12, 32, v11
    s_mul_i32 s57, s34, 3
    s_add_u32 s56, s56, s57
    s_lshl_b32 s56, s56, 12
    s_add_u32 s44, s56, s43
    s_add_u32 s56, s68, 1
    s_cmp_ge_u32 s56, 3
    s_cselect_b32 s57, 3, 0
    s_sub_u32 s56, s56, s57
    s_lshl_b32 s57, s56, 6
    s_add_u32 s57, s57, 0x15000
    v_add_u32 v13, s57, v144
    v_xor_b32 v14, 32, v13
    s_mul_i32 s57, s34, 3
    s_add_u32 s56, s56, s57
    s_lshl_b32 s56, s56, 12
    s_add_u32 s45, s56, s43
    buffer_load_dwordx4 v29, s[4:7], s86 offen offset:3072 lds
    s_add_u32 s56, s68, 2
    s_cmp_ge_u32 s56, 3
    s_cselect_b32 s57, 3, 0
    s_sub_u32 s56, s56, s57
    s_lshl_b32 s57, s56, 6
    s_add_u32 s57, s57, 0x15000
    v_add_u32 v15, s57, v144
    v_xor_b32 v16, 32, v15
    s_mul_i32 s57, s34, 3
    s_add_u32 s56, s56, s57
    s_lshl_b32 s56, s56, 12
    s_add_u32 s46, s56, s43
    v_mov_b32 v144, 0x3f803f80
    v_accvgpr_write_b32 a240, v144
    v_accvgpr_write_b32 a241, v144
    v_accvgpr_write_b32 a242, v144
    v_accvgpr_write_b32 a243, v144
    s_lshr_b32 s56, s61, 2
    s_lshl_b32 s56, s56, 12
    s_add_u32 m0, s41, 0x3000
    s_nop 0
    buffer_load_dwordx4 v8, s[16:19], s40 offen lds
    s_and_b32 s57, s61, 3
    s_lshl_b32 s57, s57, 8
    s_add_u32 s56, s56, s57
    s_add_u32 s56, s56, 0x10000
    s_cmp_lt_u32 s2, 240
    s_cselect_b32 s56, s56, 0x70000000
    s_lshl_b32 s57, s62, 10
    s_add_u32 s64, s56, s57
    s_lshl_b32 s57, s62, 6
    s_add_u32 s57, s57, 0xc00
    s_add_u32 s65, s56, s57
    s_cmp_eq_u32 s62, 2
    s_cselect_b32 s93, s65, 0x70000000
    s_mov_b32 s58, 0x28000
    s_mov_b32 s59, 0x14000
    v_mul_u32_u24 v144, 0x500, v153
    v_add_u32 v144, 0x21000, v144
    s_lshl_b32 s56, s32, 2
    s_add_u32 s56, s56, 0
    v_add_u32 v145, s56, v141
    buffer_load_dwordx4 v9, s[16:19], s40 offen offset:1024 lds
    v_mul_u32_u24 v146, 40, v145
    v_lshl_add_u32 v146, v154, 3, v146
    v_add_u32 v156, v144, v146
    v_lshlrev_b32 v147, 4, v151
    v_lshrrev_b32 v146, 1, v145
    v_mad_u32_u24 v147, v146, s58, v147
    v_and_b32 v145, 1, v145
    v_mad_u32_u24 v155, v145, s59, v147
    s_lshl_b32 s56, s32, 2
    s_add_u32 s56, s56, 16
    v_add_u32 v145, s56, v141
    v_mul_u32_u24 v146, 40, v145
    v_lshl_add_u32 v146, v154, 3, v146
    v_add_u32 v157, v144, v146
    v_lshlrev_b32 v147, 4, v151
    v_lshrrev_b32 v146, 1, v145
    v_mad_u32_u24 v147, v146, s58, v147
    v_and_b32 v145, 1, v145
    buffer_load_dwordx4 v10, s[16:19], s40 offen offset:2048 lds
    s_add_u32 s85, s85, 1
    s_cmp_eq_u32 s85, 10
    s_cselect_b32 s85, 0, s85
    s_lshl_b32 s86, s85, 7
    s_add_u32 s86, s86, s38
    s_mul_i32 s40, s85, 0x30000
    s_add_u32 s40, s40, s87
    v_mad_u32_u24 v169, v145, s59, v147
    s_and_b32 s56, s32, 1
    s_lshl_b32 s56, s56, 4
    v_lshl_add_u32 v148, v141, 2, s56
    v_add_u32 v145, v148, v154
    v_mul_u32_u24 v146, 40, v145
    v_add3_u32 v158, v144, v146, 32
    v_add_u32 v145, v148, v153
    v_lshlrev_b32 v147, 4, v154
    v_lshrrev_b32 v146, 1, v145
    v_mad_u32_u24 v147, v146, s58, v147
    v_and_b32 v145, 1, v145
    v_mad_u32_u24 v171, v145, s59, v147
    s_cmp_lt_u32 s32, 2
    s_cselect_b64 vcc, -1, 0
    v_cndmask_b32 v171, v150, v171, vcc
    s_waitcnt vmcnt(10)
    v_readfirstlane_b32 s37, v27
    v_mov_b32 v250, 0x3f803f80
    s_mul_i32 s37, s37, 0x19660d
    s_add_u32 s37, s37, 0x3c6ef35f
    s_cmp_eq_u32 s32, 0
    s_cselect_b32 s81, s37, 0
    v_mov_b32 v27, s37
    v_lshlrev_b32 v226, 16, v236
    v_and_b32 v251, 31, v1
    v_cmp_gt_u32 vcc, 32, v1
    v_readlane_b32 s56, v226, 0
    v_readlane_b32 s57, v226, 32
    s_nop 1
    v_mov_b32 v226, s57
    v_mov_b32 v248, s56
    v_cndmask_b32 v248, v226, v248, vcc
    v_cmp_gt_u32 vcc, 16, v251
    v_cmp_eq_u32 s[98:99], 0, v251
    v_lshlrev_b32 v251, 3, v233
    v_cndmask_b32 v250, 0, v248, vcc
    v_add_u32 v251, 0x3800, v251
    v_lshlrev_b32 v252, 16, v236
    v_and_b32 v253, 0xffff0000, v236
    v_pk_add_f32 v[224:225], v[252:253], v[248:249] op_sel_hi:[1,0] neg_lo:[0,1] neg_hi:[0,1]
    v_pk_mul_f32 v[254:255], v[224:225], v[224:225]
    v_lshlrev_b32 v252, 16, v237
    v_and_b32 v253, 0xffff0000, v237
    v_pk_add_f32 v[252:253], v[252:253], v[248:249] op_sel_hi:[1,0] neg_lo:[0,1] neg_hi:[0,1]
    v_pk_fma_f32 v[254:255], v[252:253], v[252:253], v[254:255]
    v_pk_add_f32 v[224:225], v[224:225], v[252:253]
    v_lshlrev_b32 v252, 16, v238
    v_and_b32 v253, 0xffff0000, v238
    v_pk_add_f32 v[252:253], v[252:253], v[248:249] op_sel_hi:[1,0] neg_lo:[0,1] neg_hi:[0,1]
    v_pk_fma_f32 v[254:255], v[252:253], v[252:253], v[254:255]
    v_pk_add_f32 v[224:225], v[224:225], v[252:253]
    v_lshlrev_b32 v252, 16, v239
    v_and_b32 v253, 0xffff0000, v239
    v_pk_add_f32 v[252:253], v[252:253], v[248:249] op_sel_hi:[1,0] neg_lo:[0,1] neg_hi:[0,1]
    v_pk_fma_f32 v[254:255], v[252:253], v[252:253], v[254:255]
    v_pk_add_f32 v[224:225], v[224:225], v[252:253]
    v_lshlrev_b32 v252, 16, v240
    v_and_b32 v253, 0xffff0000, v240
    v_pk_add_f32 v[252:253], v[252:253], v[248:249] op_sel_hi:[1,0] neg_lo:[0,1] neg_hi:[0,1]
    v_pk_fma_f32 v[254:255], v[252:253], v[252:253], v[254:255]
    v_pk_add_f32 v[224:225], v[224:225], v[252:253]
    v_lshlrev_b32 v252, 16, v241
    v_and_b32 v253, 0xffff0000, v241
    v_pk_add_f32 v[252:253], v[252:253], v[248:249] op_sel_hi:[1,0] neg_lo:[0,1] neg_hi:[0,1]
    v_pk_fma_f32 v[254:255], v[252:253], v[252:253], v[254:255]
    v_pk_add_f32 v[224:225], v[224:225], v[252:253]
    v_lshlrev_b32 v252, 16, v242
    v_and_b32 v253, 0xffff0000, v242
    v_pk_add_f32 v[252:253], v[252:253], v[248:249] op_sel_hi:[1,0] neg_lo:[0,1] neg_hi:[0,1]
    v_pk_fma_f32 v[254:255], v[252:253], v[252:253], v[254:255]
    v_pk_add_f32 v[224:225], v[224:225], v[252:253]
    v_lshlrev_b32 v252, 16, v243
    v_and_b32 v253, 0xffff0000, v243
    v_pk_add_f32 v[252:253], v[252:253], v[248:249] op_sel_hi:[1,0] neg_lo:[0,1] neg_hi:[0,1]
    v_pk_fma_f32 v[254:255], v[252:253], v[252:253], v[254:255]
    v_pk_add_f32 v[224:225], v[224:225], v[252:253]
    v_lshlrev_b32 v252, 16, v244
    v_and_b32 v253, 0xffff0000, v244
    v_pk_add_f32 v[252:253], v[252:253], v[250:251] op_sel_hi:[1,0] neg_lo:[0,1] neg_hi:[0,1]
    v_pk_fma_f32 v[254:255], v[252:253], v[252:253], v[254:255]
    v_pk_add_f32 v[224:225], v[224:225], v[252:253]
    v_lshlrev_b32 v252, 16, v245
    v_and_b32 v253, 0xffff0000, v245
    v_pk_add_f32 v[252:253], v[252:253], v[250:251] op_sel_hi:[1,0] neg_lo:[0,1] neg_hi:[0,1]
    v_pk_fma_f32 v[254:255], v[252:253], v[252:253], v[254:255]
    v_pk_add_f32 v[224:225], v[224:225], v[252:253]
    v_lshlrev_b32 v252, 16, v246
    v_and_b32 v253, 0xffff0000, v246
    v_pk_add_f32 v[252:253], v[252:253], v[250:251] op_sel_hi:[1,0] neg_lo:[0,1] neg_hi:[0,1]
    v_pk_fma_f32 v[254:255], v[252:253], v[252:253], v[254:255]
    v_pk_add_f32 v[224:225], v[224:225], v[252:253]
    v_lshlrev_b32 v252, 16, v247
    v_and_b32 v253, 0xffff0000, v247
    v_pk_add_f32 v[252:253], v[252:253], v[250:251] op_sel_hi:[1,0] neg_lo:[0,1] neg_hi:[0,1]
    v_pk_fma_f32 v[254:255], v[252:253], v[252:253], v[254:255]
    v_pk_add_f32 v[224:225], v[224:225], v[252:253]
    v_add_f32 v226, v224, v225
    v_add_f32 v249, v254, v255
    v_cndmask_b32 v251, v150, v251, s[98:99]
    v_add_f32_dpp v226, v226, v226 row_ror:8 row_mask:0xf bank_mask:0xf
    v_add_f32_dpp v249, v249, v249 row_ror:8 row_mask:0xf bank_mask:0xf
    s_nop 0
    v_add_f32_dpp v226, v226, v226 row_ror:4 row_mask:0xf bank_mask:0xf
    v_add_f32_dpp v249, v249, v249 row_ror:4 row_mask:0xf bank_mask:0xf
    s_nop 0
    v_add_f32_dpp v226, v226, v226 row_ror:2 row_mask:0xf bank_mask:0xf
    v_add_f32_dpp v249, v249, v249 row_ror:2 row_mask:0xf bank_mask:0xf
    s_nop 0
    v_add_f32_dpp v226, v226, v226 row_ror:1 row_mask:0xf bank_mask:0xf
    v_add_f32_dpp v249, v249, v249 row_ror:1 row_mask:0xf bank_mask:0xf
    v_mov_b32 v252, v226
    v_mov_b32 v253, v249
    s_nop 0
    v_permlane16_swap_b32 v226, v252
    v_permlane16_swap_b32 v249, v253
    v_add_f32 v226, v226, v252
    v_add_f32 v249, v249, v253
    v_mul_f32 v226, 0x3acccccd, v226
    v_mul_f32 v250, 0x3acccccd, v249
    v_fma_f32 v250, -v226, v226, v250
    v_max_f32 v250, 0, v250
    v_add_f32 v226, v226, v248
    v_cvt_pk_bf16_f32 v250, v250, v250
    v_lshlrev_b32 v250, 16, v250
    v_add_f32 v250, 0x3727c5ac, v250
    v_cvt_pk_bf16_f32 v250, v250, v250
    v_lshlrev_b32 v250, 16, v250
    v_sqrt_f32 v250, v250
    s_nop 0
    v_cvt_pk_bf16_f32 v236, v226, v250
    v_mov_b32 v237, s37
    buffer_store_dwordx2 v[236:237], v251, s[28:31], 0 offen sc1
    s_barrier
    ds_read_b128 a[0:3], v6
    ds_read_b128 a[4:7], v6 offset:1024
    ds_read_b64_tr_b16 v[40:41], v11
    ds_read_b64_tr_b16 v[42:43], v11 offset:768
    ds_read_b64_tr_b16 v[44:45], v12
    ds_read_b64_tr_b16 v[46:47], v12 offset:768
    ds_read_b64_tr_b16 v[48:49], v13
    ds_read_b64_tr_b16 v[50:51], v13 offset:768
    ds_read_b64_tr_b16 v[52:53], v14
    ds_read_b64_tr_b16 v[54:55], v14 offset:768
    ds_read_b64_tr_b16 v[56:57], v15
    ds_read_b64_tr_b16 v[58:59], v15 offset:768
    ds_read_b64_tr_b16 v[60:61], v16
    ds_read_b64_tr_b16 v[62:63], v16 offset:768
    s_waitcnt lgkmcnt(10)
    v_mfma_f32_16x16x32_bf16 v[64:67], v[40:43], a[0:3], 0
    s_lshr_b32 s58, s2, 2
    ds_read_b128 a[8:11], v7
    ds_read_b128 a[12:15], v7 offset:1024
    s_lshl_b32 s58, s58, 4
    s_and_b32 s56, s2, 3
    v_mfma_f32_16x16x32_bf16 v[68:71], v[40:43], a[4:7], 0
    s_add_u32 m0, s39, 0x2000
    s_lshl2_add_u32 s58, s56, s58
    s_add_u32 s58, s58, 0x1000
    v_cmp_eq_u32 vcc, 0, v0
    v_mov_b32 v144, s58
    v_mfma_f32_16x16x32_bf16 v[128:131], v[40:43], a[240:243], 0
    s_waitcnt lgkmcnt(10)
    ds_read_b64_tr_b16 v[40:41], v11 offset:6144
    ds_read_b64_tr_b16 v[42:43], v11 offset:6912
    buffer_load_dwordx4 v4, s[4:7], s86 offen lds
    v_mfma_f32_16x16x32_bf16 v[76:79], v[44:47], a[4:7], 0
    s_cmp_eq_u32 s32, 0
    s_cselect_b32 s96, 0, 0x70000000
    buffer_load_dwordx4 v5, s[4:7], s86 offen offset:1024 lds
    v_cndmask_b32 v25, v150, v144, vcc
    v_mfma_f32_16x16x32_bf16 v[72:75], v[44:47], a[0:3], 0
    s_add_u32 s96, s96, 0x1000
    buffer_load_dwordx4 v28, s[4:7], s86 offen offset:2048 lds
    v_lshl_add_u32 v24, v1, 4, s96
    v_lshrrev_b32 v148, 3, v1
    v_mfma_f32_16x16x32_bf16 v[132:135], v[44:47], a[240:243], 0
    s_waitcnt lgkmcnt(4)
    ds_read_b64_tr_b16 v[44:45], v12 offset:6144
    ds_read_b64_tr_b16 v[46:47], v12 offset:6912
    buffer_load_dwordx4 v29, s[4:7], s86 offen offset:3072 lds
    v_mfma_f32_16x16x32_bf16 v[80:83], v[48:51], a[0:3], 0
    s_add_u32 m0, s41, 0x6000
    s_nop 0
    buffer_load_dwordx4 v8, s[16:19], s40 offen lds
    v_and_b32 v149, 3, v148
    v_lshrrev_b32 v148, 2, v148
    v_mfma_f32_16x16x32_bf16 v[84:87], v[48:51], a[4:7], 0
    ds_read_b64_tr_b16 v[48:49], v13 offset:6144
    ds_read_b64_tr_b16 v[50:51], v13 offset:6912
    buffer_load_dwordx4 v9, s[16:19], s40 offen offset:1024 lds
    v_mul_u32_u24 v149, 0x500, v149
    v_mfma_f32_16x16x32_bf16 v[92:95], v[52:55], a[4:7], 0
    s_mov_b32 s67, 0x55000
    buffer_load_dwordx4 v10, s[16:19], s40 offen offset:2048 lds
    v_and_b32 v144, 7, v1
    v_lshl_add_u32 v149, v144, 4, v149
    v_mfma_f32_16x16x32_bf16 v[88:91], v[52:55], a[0:3], 0
    ds_read_b64_tr_b16 v[52:53], v14 offset:6144
    ds_read_b64_tr_b16 v[54:55], v14 offset:6912
    s_add_u32 s85, s85, 1
    s_cmp_eq_u32 s85, 10
    s_cselect_b32 s85, 0, s85
    s_lshl_b32 s86, s85, 7
    s_add_u32 s86, s86, s38
    s_mul_i32 s40, s85, 0x30000
    s_add_u32 s40, s40, s87
    s_add_u32 m0, s39, 0x3000
    s_nop 0
    buffer_load_dwordx4 v4, s[4:7], s86 offen lds
    v_mfma_f32_16x16x32_bf16 v[96:99], v[56:59], a[0:3], 0
    s_mul_i32 s56, s32, 0x300
    buffer_load_dwordx4 v5, s[4:7], s86 offen offset:1024 lds
    s_add_u32 s56, s56, s2
    s_mul_i32 s57, s56, 0x199a
    v_mfma_f32_16x16x32_bf16 v[100:103], v[56:59], a[4:7], 0
    s_lshr_b32 s57, s57, 16
    ds_read_b64_tr_b16 v[56:57], v15 offset:6144
    ds_read_b64_tr_b16 v[58:59], v15 offset:6912
    buffer_load_dwordx4 v28, s[4:7], s86 offen offset:2048 lds
    v_mfma_f32_16x16x32_bf16 v[108:111], v[60:63], a[4:7], 0
    s_mul_i32 s58, s57, 10
    buffer_load_dwordx4 v29, s[4:7], s86 offen offset:3072 lds
    s_sub_u32 s58, s56, s58
    s_lshr_b32 s59, s57, 2
    v_mfma_f32_16x16x32_bf16 v[104:107], v[60:63], a[0:3], 0
    s_waitcnt lgkmcnt(4)
    ds_read_b64_tr_b16 v[60:61], v16 offset:6144
    ds_read_b64_tr_b16 v[62:63], v16 offset:6912
    s_add_u32 m0, s41, 0x9000
    s_nop 0
    buffer_load_dwordx4 v8, s[16:19], s40 offen lds
    v_mfma_f32_16x16x32_bf16 v[64:67], v[40:43], a[8:11], v[64:67]
    s_mul_i32 s61, s59, 0x1400
    buffer_load_dwordx4 v9, s[16:19], s40 offen offset:1024 lds
    s_and_b32 s60, s57, 3
    s_lshl_b32 s76, s60, 8
    v_mfma_f32_16x16x32_bf16 v[68:71], v[40:43], a[12:15], v[68:71]
    s_add_u32 s61, s61, s76
    buffer_load_dwordx4 v10, s[16:19], s40 offen offset:2048 lds
    s_add_u32 s61, s61, 0x290000
    s_lshl_b32 s60, s60, 2
    s_lshl_b32 s76, s59, 5
    v_mfma_f32_16x16x32_bf16 v[128:131], v[40:43], a[240:243], v[128:131]
    s_add_u32 s85, s85, 1
    s_cmp_eq_u32 s85, 10
    s_cselect_b32 s85, 0, s85
    s_add_u32 s76, s76, s60
    s_sub_u32 s59, s59, 48
    v_mfma_f32_16x16x32_bf16 v[76:79], v[44:47], a[12:15], v[76:79]
    s_lshl_b32 s86, s85, 7
    s_add_u32 s86, s86, s38
    s_mul_i32 s59, s59, 40
    s_add_u32 s59, s59, s60
    s_sub_u32 s60, s57, 0x100
    v_mfma_f32_16x16x32_bf16 v[72:75], v[44:47], a[8:11], v[72:75]
    s_mul_i32 s40, s85, 0x30000
    s_add_u32 s40, s40, s87
    s_mul_i32 s60, s60, 40
    s_add_u32 s60, s60, 16
    v_mfma_f32_16x16x32_bf16 v[132:135], v[44:47], a[240:243], v[132:135]
    s_waitcnt vmcnt(15) lgkmcnt(0)
    s_barrier
    ds_read_b128 a[16:19], v6 offset:4096
    ds_read_b128 a[20:23], v6 offset:5120
    s_cmp_lt_u32 s57, 256
    s_cselect_b32 s59, s59, s60
    v_mfma_f32_16x16x32_bf16 v[80:83], v[48:51], a[8:11], v[80:83]
    s_add_u32 m0, s39, 0
    ds_read_b64_tr_b16 v[40:41], v11 offset:12288
    ds_read_b64_tr_b16 v[42:43], v11 offset:13056
    s_cmp_lt_u32 s57, 192
    s_cselect_b32 s76, s76, s59
    v_mfma_f32_16x16x32_bf16 v[84:87], v[48:51], a[12:15], v[84:87]
    ds_read_b64_tr_b16 v[44:45], v12 offset:12288
    ds_read_b64_tr_b16 v[46:47], v12 offset:13056
    buffer_load_dwordx4 v4, s[4:7], s86 offen lds
    v_mfma_f32_16x16x32_bf16 v[92:95], v[52:55], a[12:15], v[92:95]
    ds_read_b64_tr_b16 v[48:49], v13 offset:12288
    ds_read_b64_tr_b16 v[50:51], v13 offset:13056
    buffer_load_dwordx4 v5, s[4:7], s86 offen offset:1024 lds
    v_mfma_f32_16x16x32_bf16 v[88:91], v[52:55], a[8:11], v[88:91]
    s_cmp_lt_u32 s57, 192
    s_cselect_b32 s59, 16, 20
    ds_read_b64_tr_b16 v[52:53], v14 offset:12288
    ds_read_b64_tr_b16 v[54:55], v14 offset:13056
    s_mul_i32 s59, s59, 0x500
    v_mad_u32_u24 v165, v148, s59, v149
    v_mfma_f32_16x16x32_bf16 v[96:99], v[56:59], a[8:11], v[96:99]
    s_mul_i32 s76, s76, 0x500
    ds_read_b64_tr_b16 v[176:177], v156
    ds_read_b64_tr_b16 v[178:179], v156 offset:5120
    buffer_load_dwordx4 v28, s[4:7], s86 offen offset:2048 lds
    v_mfma_f32_16x16x32_bf16 v[100:103], v[56:59], a[12:15], v[100:103]
    s_lshl_b32 s59, s58, 7
    ds_read_b64_tr_b16 v[56:57], v15 offset:12288
    ds_read_b64_tr_b16 v[58:59], v15 offset:13056
    buffer_load_dwordx4 v29, s[4:7], s86 offen offset:3072 lds
    v_mfma_f32_16x16x32_bf16 v[108:111], v[60:63], a[12:15], v[108:111]
    s_add_u32 m0, s41, 0
    ds_read_b64_tr_b16 v[180:181], v157
    ds_read_b64_tr_b16 v[182:183], v157 offset:5120
    s_add_u32 s76, s76, s59
    v_mfma_f32_16x16x32_bf16 v[104:107], v[60:63], a[8:11], v[104:107]
    s_waitcnt lgkmcnt(10)
    ds_read_b64_tr_b16 v[60:61], v16 offset:12288
    ds_read_b64_tr_b16 v[62:63], v16 offset:13056
    buffer_load_dwordx4 v8, s[16:19], s40 offen lds
    v_mfma_f32_16x16x32_bf16 v[64:67], v[40:43], a[16:19], v[64:67]
    ds_read_b128 a[24:27], v7 offset:4096
    ds_read_b128 a[28:31], v7 offset:5120
    buffer_load_dwordx4 v9, s[16:19], s40 offen offset:1024 lds
    v_mfma_f32_16x16x32_bf16 v[68:71], v[40:43], a[20:23], v[68:71]
    s_cmp_lt_u32 s56, 2720
    s_cselect_b32 s76, s76, 0x70000000
    ds_read_b64_tr_b16 v[184:185], v158
    ds_read_b64_tr_b16 v[186:187], v158 offset:5120
    v_mfma_f32_16x16x32_bf16 v[128:131], v[40:43], a[240:243], v[128:131]
    ds_read_b64_tr_b16 v[40:41], v11 offset:18432
    ds_read_b64_tr_b16 v[42:43], v11 offset:19200
    buffer_load_dwordx4 v10, s[16:19], s40 offen offset:2048 lds
    v_mfma_f32_16x16x32_bf16 v[76:79], v[44:47], a[20:23], v[76:79]
    s_add_u32 s85, s85, 1
    s_cmp_eq_u32 s85, 10
    s_cselect_b32 s85, 0, s85
    s_lshl_b32 s86, s85, 7
    s_add_u32 s86, s86, s38
    s_mul_i32 s40, s85, 0x30000
    s_add_u32 s40, s40, s87
    s_waitcnt lgkmcnt(10)
    buffer_store_dwordx4 v[176:179], v155, s[28:31], s64 offen sc1
    v_mfma_f32_16x16x32_bf16 v[72:75], v[44:47], a[16:19], v[72:75]
    s_cmp_lt_u32 s56, 2720
    s_cselect_b32 s61, s61, 0x70000000
    s_lshl_b32 s58, s58, 2
    v_add_u32 v145, s58, v141
    v_mul_u32_u24 v146, 52, v145
    v_mfma_f32_16x16x32_bf16 v[132:135], v[44:47], a[240:243], v[132:135]
    ds_read_b64_tr_b16 v[44:45], v12 offset:18432
    ds_read_b64_tr_b16 v[46:47], v12 offset:19200
    s_waitcnt lgkmcnt(8)
    buffer_store_dwordx4 v[180:183], v169, s[28:31], s64 offen sc1
    v_mfma_f32_16x16x32_bf16 v[80:83], v[48:51], a[16:19], v[80:83]
    v_lshrrev_b32 v146, 8, v146
    v_mul_u32_u24 v147, 5, v146
    v_sub_u32 v145, v145, v147
    v_lshlrev_b32 v145, 10, v145
    v_mfma_f32_16x16x32_bf16 v[84:87], v[48:51], a[20:23], v[84:87]
    ds_read_b64_tr_b16 v[48:49], v13 offset:18432
    ds_read_b64_tr_b16 v[50:51], v13 offset:19200
    s_waitcnt lgkmcnt(6)
    buffer_store_dwordx4 v[184:187], v171, s[28:31], s65 offen sc1
    v_mfma_f32_16x16x32_bf16 v[92:95], v[52:55], a[20:23], v[92:95]
    s_mul_i32 s56, s32, 0x300
    buffer_store_dwordx4 v[184:187], v171, s[28:31], s93 offen offset:64 sc1
    v_lshl_add_u32 v145, v151, 4, v145
    v_mad_u32_u24 v162, v146, s67, v145
    v_mfma_f32_16x16x32_bf16 v[88:91], v[52:55], a[16:19], v[88:91]
    s_cmp_ge_u32 s94, 10
    s_cselect_b32 s92, 0xfffffff6, 0
    ds_read_b64_tr_b16 v[52:53], v14 offset:18432
    ds_read_b64_tr_b16 v[54:55], v14 offset:19200
    s_add_u32 s92, s92, s94
    s_lshl_b32 s92, s92, 7
    s_add_u32 m0, s95, 0
    v_mfma_f32_16x16x32_bf16 v[96:99], v[56:59], a[16:19], v[96:99]
    s_add_u32 s56, s56, s2
    buffer_load_dwordx4 v168, s[4:7], s92 offen lds
    s_add_u32 s56, s56, 0x100
    s_mul_i32 s57, s56, 0x199a
    v_mfma_f32_16x16x32_bf16 v[100:103], v[56:59], a[20:23], v[100:103]
    ds_read_b64_tr_b16 v[56:57], v15 offset:18432
    ds_read_b64_tr_b16 v[58:59], v15 offset:19200
    s_cmp_ge_u32 s94, 9
    s_cselect_b32 s92, 0xfffffff7, 1
    s_add_u32 s92, s92, s94
    s_lshl_b32 s92, s92, 7
    s_add_u32 m0, s95, 0x800
    s_nop 0
    buffer_load_dwordx4 v168, s[4:7], s92 offen lds
    v_mfma_f32_16x16x32_bf16 v[108:111], v[60:63], a[20:23], v[108:111]
    s_cmp_ge_u32 s94, 8
    s_cselect_b32 s92, 0xfffffff8, 2
    s_add_u32 s92, s92, s94
    s_lshl_b32 s92, s92, 7
    s_add_u32 m0, s95, 0x1000
    v_mfma_f32_16x16x32_bf16 v[104:107], v[60:63], a[16:19], v[104:107]
    s_waitcnt lgkmcnt(4)
    s_lshr_b32 s57, s57, 16
    ds_read_b64_tr_b16 v[60:61], v16 offset:18432
    ds_read_b64_tr_b16 v[62:63], v16 offset:19200
    buffer_load_dwordx4 v168, s[4:7], s92 offen lds
    v_mfma_f32_16x16x32_bf16 v[64:67], v[40:43], a[24:27], v[64:67]
    s_cmp_ge_u32 s94, 7
    s_cselect_b32 s92, 0xfffffff9, 3
    s_add_u32 s92, s92, s94
    s_lshl_b32 s92, s92, 7
    s_add_u32 m0, s95, 0x1800
    s_nop 0
    buffer_load_dwordx4 v168, s[4:7], s92 offen lds
    v_mfma_f32_16x16x32_bf16 v[68:71], v[40:43], a[28:31], v[68:71]
    s_cmp_ge_u32 s94, 6
    s_cselect_b32 s92, 0xfffffffa, 4
    s_add_u32 s92, s92, s94
    s_lshl_b32 s92, s92, 7
    s_add_u32 m0, s95, 0x2000
    v_mfma_f32_16x16x32_bf16 v[128:131], v[40:43], a[240:243], v[128:131]
    s_mul_i32 s58, s57, 10
    buffer_load_dwordx4 v168, s[4:7], s92 offen lds
    s_sub_u32 s58, s56, s58
    s_lshr_b32 s59, s57, 2
    v_mfma_f32_16x16x32_bf16 v[76:79], v[44:47], a[28:31], v[76:79]
    s_mul_i32 s62, s59, 0x1400
    s_and_b32 s60, s57, 3
    s_lshl_b32 s77, s60, 8
    s_add_u32 s62, s62, s77
    s_add_u32 s62, s62, 0x290000
    v_mfma_f32_16x16x32_bf16 v[72:75], v[44:47], a[24:27], v[72:75]
    s_lshl_b32 s60, s60, 2
    s_lshl_b32 s77, s59, 5
    s_add_u32 s77, s77, s60
    s_sub_u32 s59, s59, 48
    s_mul_i32 s59, s59, 40
    v_mfma_f32_16x16x32_bf16 v[132:135], v[44:47], a[240:243], v[132:135]
    s_waitcnt vmcnt(23) lgkmcnt(0)
    s_barrier
    ds_read_b128 a[32:35], v6 offset:8192
    ds_read_b128 a[36:39], v6 offset:9216
    s_add_u32 s59, s59, s60
    s_sub_u32 s60, s57, 0x100
    s_mul_i32 s60, s60, 40
    v_mfma_f32_16x16x32_bf16 v[80:83], v[48:51], a[24:27], v[80:83]
    s_add_u32 m0, s39, 0x1000
    ds_read_b64_tr_b16 v[40:41], v11 offset:24576
    ds_read_b64_tr_b16 v[42:43], v11 offset:25344
    s_add_u32 s60, s60, 16
    v_mfma_f32_16x16x32_bf16 v[84:87], v[48:51], a[28:31], v[84:87]
    ds_read_b64_tr_b16 v[44:45], v12 offset:24576
    ds_read_b64_tr_b16 v[46:47], v12 offset:25344
    buffer_load_dwordx4 v4, s[4:7], s86 offen lds
    v_mfma_f32_16x16x32_bf16 v[92:95], v[52:55], a[28:31], v[92:95]
    s_cmp_lt_u32 s57, 256
    s_cselect_b32 s59, s59, s60
    ds_read_b64_tr_b16 v[48:49], v13 offset:24576
    ds_read_b64_tr_b16 v[50:51], v13 offset:25344
    v_mfma_f32_16x16x32_bf16 v[88:91], v[52:55], a[24:27], v[88:91]
    s_cmp_lt_u32 s57, 192
    s_cselect_b32 s77, s77, s59
    ds_read_b64_tr_b16 v[52:53], v14 offset:24576
    ds_read_b64_tr_b16 v[54:55], v14 offset:25344
    v_mfma_f32_16x16x32_bf16 v[96:99], v[56:59], a[24:27], v[96:99]
    s_cmp_lt_u32 s57, 192
    s_cselect_b32 s59, 16, 20
    buffer_load_dwordx4 v5, s[4:7], s86 offen offset:1024 lds
    s_mul_i32 s59, s59, 0x500
    v_mfma_f32_16x16x32_bf16 v[100:103], v[56:59], a[28:31], v[100:103]
    s_mul_i32 s77, s77, 0x500
    ds_read_b64_tr_b16 v[56:57], v15 offset:24576
    ds_read_b64_tr_b16 v[58:59], v15 offset:25344
    v_mad_u32_u24 v166, v148, s59, v149
    s_lshl_b32 s59, s58, 7
    v_mfma_f32_16x16x32_bf16 v[108:111], v[60:63], a[28:31], v[108:111]
    s_add_u32 s77, s77, s59
    s_cmp_lt_u32 s56, 2720
    s_cselect_b32 s77, s77, 0x70000000
    s_cmp_lt_u32 s56, 2720
    s_cselect_b32 s62, s62, 0x70000000
    v_mfma_f32_16x16x32_bf16 v[104:107], v[60:63], a[24:27], v[104:107]
    s_waitcnt lgkmcnt(6)
    s_lshl_b32 s58, s58, 2
    ds_read_b64_tr_b16 v[60:61], v16 offset:24576
    ds_read_b64_tr_b16 v[62:63], v16 offset:25344
    buffer_load_dwordx4 v28, s[4:7], s86 offen offset:2048 lds
    v_add_u32 v145, s58, v141
    v_mfma_f32_16x16x32_bf16 v[64:67], v[40:43], a[32:35], v[64:67]
    ds_read_b128 a[40:43], v7 offset:8192
    ds_read_b128 a[44:47], v7 offset:9216
    v_mul_u32_u24 v146, 52, v145
    v_lshrrev_b32 v146, 8, v146
    v_mfma_f32_16x16x32_bf16 v[68:71], v[40:43], a[36:39], v[68:71]
    v_mul_u32_u24 v147, 5, v146
    v_sub_u32 v145, v145, v147
    v_lshlrev_b32 v145, 10, v145
    v_lshl_add_u32 v145, v151, 4, v145
    v_mfma_f32_16x16x32_bf16 v[128:131], v[40:43], a[240:243], v[128:131]
    s_mul_i32 s56, s32, 0x300
    ds_read_b64_tr_b16 v[40:41], v11 offset:30720
    ds_read_b64_tr_b16 v[42:43], v11 offset:31488
    s_add_u32 s56, s56, s2
    v_mad_u32_u24 v163, v146, s67, v145
    v_mfma_f32_16x16x32_bf16 v[76:79], v[44:47], a[36:39], v[76:79]
    s_add_u32 s56, s56, 0x200
    buffer_load_dwordx4 v29, s[4:7], s86 offen offset:3072 lds
    s_mul_i32 s57, s56, 0x199a
    s_lshr_b32 s57, s57, 16
    v_mfma_f32_16x16x32_bf16 v[72:75], v[44:47], a[32:35], v[72:75]
    s_add_u32 m0, s41, 0x3000
    s_mul_i32 s58, s57, 10
    s_sub_u32 s58, s56, s58
    s_lshr_b32 s59, s57, 2
    s_mul_i32 s63, s59, 0x1400
    v_mfma_f32_16x16x32_bf16 v[132:135], v[44:47], a[240:243], v[132:135]
    s_waitcnt lgkmcnt(4)
    s_and_b32 s60, s57, 3
    ds_read_b64_tr_b16 v[44:45], v12 offset:30720
    ds_read_b64_tr_b16 v[46:47], v12 offset:31488
    s_lshl_b32 s3, s60, 8
    s_add_u32 s63, s63, s3
    v_mfma_f32_16x16x32_bf16 v[80:83], v[48:51], a[32:35], v[80:83]
    s_add_u32 s63, s63, 0x290000
    buffer_load_dwordx4 v8, s[16:19], s40 offen lds
    s_lshl_b32 s60, s60, 2
    s_lshl_b32 s3, s59, 5
    v_mfma_f32_16x16x32_bf16 v[84:87], v[48:51], a[36:39], v[84:87]
    s_add_u32 s3, s3, s60
    ds_read_b64_tr_b16 v[48:49], v13 offset:30720
    ds_read_b64_tr_b16 v[50:51], v13 offset:31488
    s_sub_u32 s59, s59, 48
    s_mul_i32 s59, s59, 40
    s_add_u32 s59, s59, s60
    v_mfma_f32_16x16x32_bf16 v[92:95], v[52:55], a[36:39], v[92:95]
    s_sub_u32 s60, s57, 0x100
    buffer_load_dwordx4 v9, s[16:19], s40 offen offset:1024 lds
    s_mul_i32 s60, s60, 40
    s_add_u32 s60, s60, 16
    v_mfma_f32_16x16x32_bf16 v[88:91], v[52:55], a[32:35], v[88:91]
    s_cmp_lt_u32 s57, 256
    s_cselect_b32 s59, s59, s60
    ds_read_b64_tr_b16 v[52:53], v14 offset:30720
    ds_read_b64_tr_b16 v[54:55], v14 offset:31488
    v_mfma_f32_16x16x32_bf16 v[96:99], v[56:59], a[32:35], v[96:99]
    s_cmp_lt_u32 s57, 192
    s_cselect_b32 s3, s3, s59
    s_cmp_lt_u32 s57, 192
    s_cselect_b32 s59, 16, 20
    s_mul_i32 s59, s59, 0x500
    v_mfma_f32_16x16x32_bf16 v[100:103], v[56:59], a[36:39], v[100:103]
    s_mul_i32 s3, s3, 0x500
    ds_read_b64_tr_b16 v[56:57], v15 offset:30720
    ds_read_b64_tr_b16 v[58:59], v15 offset:31488
    v_mad_u32_u24 v167, v148, s59, v149
    s_lshl_b32 s59, s58, 7
    v_mfma_f32_16x16x32_bf16 v[108:111], v[60:63], a[36:39], v[108:111]
    s_add_u32 s3, s3, s59
    buffer_load_dwordx4 v10, s[16:19], s40 offen offset:2048 lds
    s_cmp_lt_u32 s56, 2720
    s_cselect_b32 s3, s3, 0x70000000
    v_mfma_f32_16x16x32_bf16 v[104:107], v[60:63], a[32:35], v[104:107]
    s_waitcnt lgkmcnt(4)
    s_add_u32 s85, s85, 1
    ds_read_b64_tr_b16 v[60:61], v16 offset:30720
    ds_read_b64_tr_b16 v[62:63], v16 offset:31488
    s_cmp_lt_u32 s56, 2720
    s_cselect_b32 s63, s63, 0x70000000
    v_mfma_f32_16x16x32_bf16 v[64:67], v[40:43], a[40:43], v[64:67]
    s_cmp_eq_u32 s85, 10
    s_cselect_b32 s85, 0, s85
    s_lshl_b32 s58, s58, 2
    v_add_u32 v145, s58, v141
    v_mul_u32_u24 v146, 52, v145
    v_mfma_f32_16x16x32_bf16 v[68:71], v[40:43], a[44:47], v[68:71]
    s_lshl_b32 s86, s85, 7
    v_lshrrev_b32 v146, 8, v146
    v_mul_u32_u24 v147, 5, v146
    v_sub_u32 v145, v145, v147
    v_lshlrev_b32 v145, 10, v145
    v_lshl_add_u32 v145, v151, 4, v145
    v_mfma_f32_16x16x32_bf16 v[128:131], v[40:43], a[240:243], v[128:131]
    s_add_u32 s86, s86, s38
    s_mul_i32 s56, s32, 0xc00
    v_mad_u32_u24 v164, v146, s67, v145
    s_add_u32 s67, s56, 0x24000
    v_lshlrev_b32 v144, 7, v153
    v_mfma_f32_16x16x32_bf16 v[76:79], v[44:47], a[44:47], v[76:79]
    s_mul_i32 s40, s85, 0x30000
    s_mov_b32 s75, 0x20000
    v_lshl_add_u32 v144, v141, 5, v144
    v_lshl_add_u32 v144, v154, 3, v144
    v_add_u32 v159, s67, v144
    v_mfma_f32_16x16x32_bf16 v[72:75], v[44:47], a[40:43], v[72:75]
    s_add_u32 s40, s40, s87
    s_mul_i32 s66, s36, 0x55000
    s_add_u32 s66, s66, 0x290000
    v_mfma_f32_16x16x32_bf16 v[132:135], v[44:47], a[240:243], v[132:135]
    s_waitcnt vmcnt(12) lgkmcnt(0)
    s_barrier
    buffer_store_dword v27, v25, s[28:31], 0 offen sc1
    v_mfma_f32_16x16x32_bf16 v[80:83], v[48:51], a[40:43], v[80:83]
    s_add_u32 m0, s39, 0x2000
    ds_read_b128 a[48:51], v6 offset:12288
    ds_read_b128 a[52:55], v6 offset:13312
    v_mfma_f32_16x16x32_bf16 v[84:87], v[48:51], a[44:47], v[84:87]
    ds_read_b64_tr_b16 v[40:41], v11 offset:36864
    ds_read_b64_tr_b16 v[42:43], v11 offset:37632
    buffer_load_dwordx4 v4, s[4:7], s86 offen lds
    v_mfma_f32_16x16x32_bf16 v[92:95], v[52:55], a[44:47], v[92:95]
    s_mul_i32 s56, s32, 20
    ds_read_b64_tr_b16 v[44:45], v12 offset:36864
    ds_read_b64_tr_b16 v[46:47], v12 offset:37632
    v_mfma_f32_16x16x32_bf16 v[88:91], v[52:55], a[40:43], v[88:91]
    ds_read_b64_tr_b16 v[48:49], v13 offset:36864
    ds_read_b64_tr_b16 v[50:51], v13 offset:37632
    buffer_load_dwordx4 v5, s[4:7], s86 offen offset:1024 lds
    v_mfma_f32_16x16x32_bf16 v[96:99], v[56:59], a[40:43], v[96:99]
    s_nop 0
    ds_read_b64_tr_b16 v[52:53], v14 offset:36864
    ds_read_b64_tr_b16 v[54:55], v14 offset:37632
    v_mfma_f32_16x16x32_bf16 v[100:103], v[56:59], a[44:47], v[100:103]
    s_nop 0
    ds_read_b64_tr_b16 v[56:57], v15 offset:36864
    ds_read_b64_tr_b16 v[58:59], v15 offset:37632
    v_mfma_f32_16x16x32_bf16 v[108:111], v[60:63], a[44:47], v[108:111]
    buffer_load_dwordx4 v28, s[4:7], s86 offen offset:2048 lds
    v_mfma_f32_16x16x32_bf16 v[104:107], v[60:63], a[40:43], v[104:107]
    s_waitcnt lgkmcnt(8)
    ds_read_b64_tr_b16 v[60:61], v16 offset:36864
    ds_read_b64_tr_b16 v[62:63], v16 offset:37632
    v_add_u32 v25, 0x400, v25
    v_mfma_f32_16x16x32_bf16 v[64:67], v[40:43], a[48:51], v[64:67]
    s_nop 0
    ds_read_b128 a[56:59], v7 offset:12288
    ds_read_b128 a[60:63], v7 offset:13312
    v_mfma_f32_16x16x32_bf16 v[68:71], v[40:43], a[52:55], v[68:71]
    buffer_load_dwordx4 v29, s[4:7], s86 offen offset:3072 lds
    v_mfma_f32_16x16x32_bf16 v[128:131], v[40:43], a[240:243], v[128:131]
    s_waitcnt lgkmcnt(6)
    s_add_u32 m0, s41, 0x6000
    ds_read_b64_tr_b16 v[40:41], v11 offset:43008
    ds_read_b64_tr_b16 v[42:43], v11 offset:43776
    v_mfma_f32_16x16x32_bf16 v[76:79], v[44:47], a[52:55], v[76:79]
    buffer_load_dwordx4 v8, s[16:19], s40 offen lds
    v_mfma_f32_16x16x32_bf16 v[72:75], v[44:47], a[48:51], v[72:75]
    v_add_u32 v144, s56, v1
    v_cmp_gt_u32 vcc, 20, v1
    v_mfma_f32_16x16x32_bf16 v[132:135], v[44:47], a[240:243], v[132:135]
    s_nop 0
    ds_read_b64_tr_b16 v[44:45], v12 offset:43008
    ds_read_b64_tr_b16 v[46:47], v12 offset:43776
    v_mfma_f32_16x16x32_bf16 v[80:83], v[48:51], a[48:51], v[80:83]
    buffer_load_dwordx4 v9, s[16:19], s40 offen offset:1024 lds
    v_mfma_f32_16x16x32_bf16 v[84:87], v[48:51], a[52:55], v[84:87]
    s_nop 0
    ds_read_b64_tr_b16 v[48:49], v13 offset:43008
    ds_read_b64_tr_b16 v[50:51], v13 offset:43776
    v_mfma_f32_16x16x32_bf16 v[92:95], v[52:55], a[52:55], v[92:95]
    buffer_load_dwordx4 v10, s[16:19], s40 offen offset:2048 lds
    v_mfma_f32_16x16x32_bf16 v[88:91], v[52:55], a[48:51], v[88:91]
    s_add_u32 s85, s85, 1
    ds_read_b64_tr_b16 v[52:53], v14 offset:43008
    ds_read_b64_tr_b16 v[54:55], v14 offset:43776
    s_cmp_eq_u32 s85, 10
    s_cselect_b32 s85, 0, s85
    s_lshl_b32 s86, s85, 7
    s_add_u32 s86, s86, s38
    s_mul_i32 s40, s85, 0x30000
    s_add_u32 s40, s40, s87
    s_cmp_lt_u32 s61, 2932736
    s_cselect_b64 s[72:73], s[20:21], s[12:13]
    s_cselect_b32 s74, s22, s14
    s_add_u32 m0, s67, 0
    s_waitcnt lgkmcnt(6)
    v_mfma_f32_16x16x32_bf16 v[96:99], v[56:59], a[48:51], v[96:99]
    buffer_load_dwordx4 v165, s[72:75], s76 offen lds
    v_mfma_f32_16x16x32_bf16 v[100:103], v[56:59], a[52:55], v[100:103]
    s_cmp_lt_u32 s62, 2932736
    s_cselect_b64 s[72:73], s[20:21], s[12:13]
    s_cselect_b32 s74, s22, s14
    ds_read_b64_tr_b16 v[56:57], v15 offset:43008
    ds_read_b64_tr_b16 v[58:59], v15 offset:43776
    v_mfma_f32_16x16x32_bf16 v[108:111], v[60:63], a[52:55], v[108:111]
    s_add_u32 m0, s67, 0x400
    v_lshrrev_b32 v145, 3, v144
    v_and_b32 v144, 7, v144
    v_mfma_f32_16x16x32_bf16 v[104:107], v[60:63], a[48:51], v[104:107]
    ds_read_b64_tr_b16 v[60:61], v16 offset:43008
    ds_read_b64_tr_b16 v[62:63], v16 offset:43776
    buffer_load_dwordx4 v166, s[72:75], s77 offen lds
    v_mfma_f32_16x16x32_bf16 v[64:67], v[40:43], a[56:59], v[64:67]
    s_cmp_lt_u32 s63, 2932736
    s_cselect_b64 s[72:73], s[20:21], s[12:13]
    s_cselect_b32 s74, s22, s14
    s_add_u32 m0, s67, 0x800
    v_mfma_f32_16x16x32_bf16 v[68:71], v[40:43], a[60:63], v[68:71]
    buffer_load_dwordx4 v167, s[72:75], s3 offen lds
    v_mfma_f32_16x16x32_bf16 v[128:131], v[40:43], a[240:243], v[128:131]
    s_waitcnt lgkmcnt(4)
    v_lshlrev_b32 v144, 4, v144
    v_lshl_add_u32 v144, v145, 11, v144
    v_mfma_f32_16x16x32_bf16 v[76:79], v[44:47], a[60:63], v[76:79]
    v_add_u32 v145, 0x27800, v2
    v_cndmask_b32 v170, v145, v144, vcc
    v_mfma_f32_16x16x32_bf16 v[72:75], v[44:47], a[56:59], v[72:75]
    s_lshl2_add_u32 s56, s33, s32
    s_lshl_b32 s56, s56, 8
    s_add_u32 s56, s56, 0x3800
    v_mfma_f32_16x16x32_bf16 v[132:135], v[44:47], a[240:243], v[132:135]
    s_waitcnt vmcnt(18) lgkmcnt(0)
    s_barrier
    ds_read_b128 a[64:67], v6
    ds_read_b128 a[68:71], v6 offset:1024
    v_mfma_f32_16x16x32_bf16 v[80:83], v[48:51], a[56:59], v[80:83]
    s_add_u32 m0, s39, 0x3000
    ds_read_b64_tr_b16 v[40:41], v11
    ds_read_b64_tr_b16 v[42:43], v11 offset:768
    v_lshl_add_u32 v126, v151, 4, s56
    v_mfma_f32_16x16x32_bf16 v[84:87], v[48:51], a[60:63], v[84:87]
    ds_read_b64_tr_b16 v[44:45], v12
    ds_read_b64_tr_b16 v[46:47], v12 offset:768
    buffer_load_dwordx4 v4, s[4:7], s86 offen lds
    v_mfma_f32_16x16x32_bf16 v[92:95], v[52:55], a[60:63], v[92:95]
    s_lshl_b32 s56, s33, 10
    ds_read_b64_tr_b16 v[48:49], v13
    ds_read_b64_tr_b16 v[50:51], v13 offset:768
    v_mov_b32 v220, 0x3f803f80
    v_mfma_f32_16x16x32_bf16 v[88:91], v[52:55], a[56:59], v[88:91]
    s_max_u32 s56, s56, 0x80
    ds_read_b64_tr_b16 v[52:53], v14
    ds_read_b64_tr_b16 v[54:55], v14 offset:768
    s_add_u32 s56, s56, 0x3780
    v_mov_b32 v221, 0x3f803f80
    v_mfma_f32_16x16x32_bf16 v[96:99], v[56:59], a[56:59], v[96:99]
    buffer_load_dwordx4 v5, s[4:7], s86 offen offset:1024 lds
    v_mov_b32 v222, 0x3f803f80
    v_mov_b32 v223, 0x3f803f80
    v_mfma_f32_16x16x32_bf16 v[100:103], v[56:59], a[60:63], v[100:103]
    s_mul_i32 s89, s34, 0x28000
    ds_read_b64_tr_b16 v[56:57], v15
    ds_read_b64_tr_b16 v[58:59], v15 offset:768
    v_lshl_add_u32 v127, v151, 3, s56
    v_mfma_f32_16x16x32_bf16 v[108:111], v[60:63], a[60:63], v[108:111]
    s_add_u32 s89, s89, 0x10000
    ds_write_b128 v170, v[220:223]
    s_lshl1_add_u32 s88, s90, s32
    v_mfma_f32_16x16x32_bf16 v[104:107], v[60:63], a[56:59], v[104:107]
    s_waitcnt lgkmcnt(7)
    ds_read_b64_tr_b16 v[60:61], v16
    ds_read_b64_tr_b16 v[62:63], v16 offset:768
    buffer_load_dwordx4 v28, s[4:7], s86 offen offset:2048 lds
    v_mfma_f32_16x16x32_bf16 v[64:67], v[40:43], a[64:67], v[64:67]
    s_cmp_ge_u32 s88, 20
    s_cselect_b32 s42, 20, 0
    ds_read_b128 a[72:75], v7
    ds_read_b128 a[76:79], v7 offset:1024
    v_mfma_f32_16x16x32_bf16 v[68:71], v[40:43], a[68:71], v[68:71]
    s_sub_u32 s88, s88, s42
    s_lshl_b32 s42, s88, 12
    s_add_u32 s42, s42, s89
    v_mfma_f32_16x16x32_bf16 v[128:131], v[40:43], a[240:243], v[128:131]
    s_mul_i32 s56, s35, 0x44000
    ds_read_b64_tr_b16 v[40:41], v11 offset:6144
    ds_read_b64_tr_b16 v[42:43], v11 offset:6912
    v_mfma_f32_16x16x32_bf16 v[76:79], v[44:47], a[68:71], v[76:79]
    s_add_u32 s56, s56, 0x540000
    buffer_load_dwordx4 v29, s[4:7], s86 offen offset:3072 lds
    s_mul_i32 s57, s32, 0xc000
    v_mfma_f32_16x16x32_bf16 v[72:75], v[44:47], a[64:67], v[72:75]
    s_add_u32 m0, s41, 0x9000
    s_add_u32 s49, s56, s57
    s_lshl_b32 s57, s32, 14
    v_mfma_f32_16x16x32_bf16 v[132:135], v[44:47], a[240:243], v[132:135]
    s_waitcnt lgkmcnt(4)
    s_add_u32 s50, s56, s57
    ds_read_b64_tr_b16 v[44:45], v12 offset:6144
    ds_read_b64_tr_b16 v[46:47], v12 offset:6912
    s_add_u32 s50, s50, 0x30000
    v_mfma_f32_16x16x32_bf16 v[80:83], v[48:51], a[64:67], v[80:83]
    s_lshl_b32 s57, s32, 12
    buffer_load_dwordx4 v8, s[16:19], s40 offen lds
    v_mfma_f32_16x16x32_bf16 v[84:87], v[48:51], a[68:71], v[84:87]
    s_add_u32 s51, s56, s57
    ds_read_b64_tr_b16 v[48:49], v13 offset:6144
    ds_read_b64_tr_b16 v[50:51], v13 offset:6912
    v_mfma_f32_16x16x32_bf16 v[92:95], v[52:55], a[68:71], v[92:95]
    s_add_u32 s51, s51, 0x40000
    buffer_load_dwordx4 v9, s[16:19], s40 offen offset:1024 lds
    s_mul_i32 s57, s32, 0xf000
    v_mfma_f32_16x16x32_bf16 v[88:91], v[52:55], a[64:67], v[88:91]
    s_add_u32 s52, s66, s57
    ds_read_b64_tr_b16 v[52:53], v14 offset:6144
    ds_read_b64_tr_b16 v[54:55], v14 offset:6912
    v_mfma_f32_16x16x32_bf16 v[96:99], v[56:59], a[64:67], v[96:99]
    s_mul_i32 s57, s32, 0x5000
    s_add_u32 s53, s66, s57
    s_add_u32 s53, s53, 0x3c000
    v_mfma_f32_16x16x32_bf16 v[100:103], v[56:59], a[68:71], v[100:103]
    s_mul_i32 s57, s32, 0x1400
    ds_read_b64_tr_b16 v[56:57], v15 offset:6144
    ds_read_b64_tr_b16 v[58:59], v15 offset:6912
    s_add_u32 s54, s66, s57
    v_mfma_f32_16x16x32_bf16 v[108:111], v[60:63], a[68:71], v[108:111]
    s_add_u32 s54, s54, 0x50000
    buffer_load_dwordx4 v10, s[16:19], s40 offen offset:2048 lds
    v_mfma_f32_16x16x32_bf16 v[104:107], v[60:63], a[64:67], v[104:107]
    s_waitcnt lgkmcnt(4)
    s_add_u32 s85, s85, 1
    ds_read_b64_tr_b16 v[60:61], v16 offset:6144
    ds_read_b64_tr_b16 v[62:63], v16 offset:6912
    s_add_u32 s56, s34, 48
    v_mfma_f32_16x16x32_bf16 v[64:67], v[40:43], a[72:75], v[64:67]
    s_cmp_eq_u32 s85, 10
    s_cselect_b32 s85, 0, s85
    s_lshl_b32 s56, s56, 12
    v_mfma_f32_16x16x32_bf16 v[68:71], v[40:43], a[76:79], v[68:71]
    s_lshl_b32 s86, s85, 7
    s_add_u32 s47, s56, s43
    s_lshr_b32 s56, s34, 2
    v_mfma_f32_16x16x32_bf16 v[128:131], v[40:43], a[240:243], v[128:131]
    s_add_u32 s86, s86, s38
    s_add_u32 s56, s56, 64
    s_lshl_b32 s56, s56, 12
    s_and_b32 s57, s34, 3
    v_mfma_f32_16x16x32_bf16 v[76:79], v[44:47], a[76:79], v[76:79]
    s_mul_i32 s40, s85, 0x30000
    s_lshl_b32 s57, s57, 8
    s_add_u32 s56, s56, s57
    v_mfma_f32_16x16x32_bf16 v[72:75], v[44:47], a[72:75], v[72:75]
    s_add_u32 s40, s40, s87
    s_add_u32 s48, s56, s43
    s_mov_b64 s[0:1], 0xffff
    v_mfma_f32_16x16x32_bf16 v[132:135], v[44:47], a[240:243], v[132:135]
    s_waitcnt vmcnt(18) lgkmcnt(0)
    s_barrier
    ds_read_b128 a[80:83], v6 offset:4096
    ds_read_b128 a[84:87], v6 offset:5120
    s_mov_b32 s70, 0x10001
    v_mfma_f32_16x16x32_bf16 v[80:83], v[48:51], a[72:75], v[80:83]
    s_add_u32 m0, s39, 0
    ds_read_b64_tr_b16 v[40:41], v11 offset:12288
    ds_read_b64_tr_b16 v[42:43], v11 offset:13056
    v_mfma_f32_16x16x32_bf16 v[84:87], v[48:51], a[76:79], v[84:87]
    ds_read_b64_tr_b16 v[44:45], v12 offset:12288
    ds_read_b64_tr_b16 v[46:47], v12 offset:13056
    buffer_load_dwordx4 v4, s[4:7], s86 offen lds
    v_mfma_f32_16x16x32_bf16 v[92:95], v[52:55], a[76:79], v[92:95]
    s_mov_b32 s71, 0x10001
    ds_read_b64_tr_b16 v[48:49], v13 offset:12288
    ds_read_b64_tr_b16 v[50:51], v13 offset:13056
    v_mfma_f32_16x16x32_bf16 v[88:91], v[52:55], a[72:75], v[88:91]
    s_mov_b32 s78, 0x3ea52b5c
    ds_read_b64_tr_b16 v[52:53], v14 offset:12288
    ds_read_b64_tr_b16 v[54:55], v14 offset:13056
    v_mfma_f32_16x16x32_bf16 v[96:99], v[56:59], a[72:75], v[96:99]
    s_add_u32 s56, s32, 0
    buffer_load_dwordx4 v5, s[4:7], s86 offen offset:1024 lds
    s_and_b32 s56, s56, 3
    v_mfma_f32_16x16x32_bf16 v[100:103], v[56:59], a[76:79], v[100:103]
    s_lshl_b32 s56, s56, 10
    ds_read_b64_tr_b16 v[56:57], v15 offset:12288
    ds_read_b64_tr_b16 v[58:59], v15 offset:13056
    v_mfma_f32_16x16x32_bf16 v[108:111], v[60:63], a[76:79], v[108:111]
    s_add_u32 s56, s56, 0x5000
    v_add_u32 v19, s56, v2
    s_add_u32 s56, s32, 1
    v_mfma_f32_16x16x32_bf16 v[104:107], v[60:63], a[72:75], v[104:107]
    s_waitcnt lgkmcnt(6)
    ds_read_b64_tr_b16 v[60:61], v16 offset:12288
    ds_read_b64_tr_b16 v[62:63], v16 offset:13056
    buffer_load_dwordx4 v28, s[4:7], s86 offen offset:2048 lds
    v_mfma_f32_16x16x32_bf16 v[64:67], v[40:43], a[80:83], v[64:67]
    s_and_b32 s56, s56, 3
    ds_read_b128 a[88:91], v7 offset:4096
    ds_read_b128 a[92:95], v7 offset:5120
    v_mfma_f32_16x16x32_bf16 v[68:71], v[40:43], a[84:87], v[68:71]
    s_lshl_b32 s56, s56, 10
    s_add_u32 s56, s56, 0x5000
    v_add_u32 v20, s56, v2
    s_add_u32 s56, s32, 2
    v_mfma_f32_16x16x32_bf16 v[128:131], v[40:43], a[240:243], v[128:131]
    s_and_b32 s56, s56, 3
    ds_read_b64_tr_b16 v[40:41], v11 offset:18432
    ds_read_b64_tr_b16 v[42:43], v11 offset:19200
    v_mfma_f32_16x16x32_bf16 v[76:79], v[44:47], a[84:87], v[76:79]
    s_lshl_b32 s56, s56, 10
    buffer_load_dwordx4 v29, s[4:7], s86 offen offset:3072 lds
    v_mfma_f32_16x16x32_bf16 v[72:75], v[44:47], a[80:83], v[72:75]
    s_add_u32 m0, s41, 0
    s_add_u32 s56, s56, 0x5000
    v_add_u32 v21, s56, v2
    s_add_u32 s56, s32, 3
    v_mfma_f32_16x16x32_bf16 v[132:135], v[44:47], a[240:243], v[132:135]
    s_waitcnt lgkmcnt(4)
    s_and_b32 s56, s56, 3
    ds_read_b64_tr_b16 v[44:45], v12 offset:18432
    ds_read_b64_tr_b16 v[46:47], v12 offset:19200
    v_mfma_f32_16x16x32_bf16 v[80:83], v[48:51], a[80:83], v[80:83]
    s_lshl_b32 s56, s56, 10
    buffer_load_dwordx4 v8, s[16:19], s40 offen lds
    v_mfma_f32_16x16x32_bf16 v[84:87], v[48:51], a[84:87], v[84:87]
    s_add_u32 s56, s56, 0x5000
    ds_read_b64_tr_b16 v[48:49], v13 offset:18432
    ds_read_b64_tr_b16 v[50:51], v13 offset:19200
    v_add_u32 v22, s56, v2
    v_mfma_f32_16x16x32_bf16 v[92:95], v[52:55], a[84:87], v[92:95]
    buffer_load_dwordx4 v9, s[16:19], s40 offen offset:1024 lds
    v_mfma_f32_16x16x32_bf16 v[88:91], v[52:55], a[80:83], v[88:91]
    ds_read_b64_tr_b16 v[52:53], v14 offset:18432
    ds_read_b64_tr_b16 v[54:55], v14 offset:19200
    v_lshlrev_b32 v144, 2, v141
    v_mfma_f32_16x16x32_bf16 v[96:99], v[56:59], a[80:83], v[96:99]
    s_or_b32 s56, s33, s32
    v_sub_u32 v144, v151, v144
    v_mov_b32 v146, 0xf149f2ca
    v_mfma_f32_16x16x32_bf16 v[100:103], v[56:59], a[84:87], v[100:103]
    s_nop 0
    ds_read_b64_tr_b16 v[56:57], v15 offset:18432
    ds_read_b64_tr_b16 v[58:59], v15 offset:19200
    v_mfma_f32_16x16x32_bf16 v[108:111], v[60:63], a[84:87], v[108:111]
    s_cmp_eq_u32 s56, 0
    s_cselect_b32 s56, 0, 2
    buffer_load_dwordx4 v10, s[16:19], s40 offen offset:2048 lds
    v_mfma_f32_16x16x32_bf16 v[104:107], v[60:63], a[80:83], v[104:107]
    s_waitcnt lgkmcnt(4)
    s_add_u32 s85, s85, 1
    ds_read_b64_tr_b16 v[60:61], v16 offset:18432
    ds_read_b64_tr_b16 v[62:63], v16 offset:19200
    v_mfma_f32_16x16x32_bf16 v[64:67], v[40:43], a[88:91], v[64:67]
    s_cmp_eq_u32 s85, 10
    s_cselect_b32 s85, 0, s85
    v_cmp_gt_u32 vcc, s56, v141
    v_mfma_f32_16x16x32_bf16 v[68:71], v[40:43], a[92:95], v[68:71]
    s_lshl_b32 s86, s85, 7
    v_cndmask_b32 v147, v146, v143, vcc
    v_subrev_u32 v145, 0, v144
    v_cmp_gt_u32 vcc, 8, v145
    v_mfma_f32_16x16x32_bf16 v[128:131], v[40:43], a[240:243], v[128:131]
    s_add_u32 s86, s86, s38
    v_cmp_gt_i32 s[56:57], 0, v145
    v_cndmask_b32 v36, v146, v143, vcc
    v_mfma_f32_16x16x32_bf16 v[76:79], v[44:47], a[92:95], v[76:79]
    s_mul_i32 s40, s85, 0x30000
    v_cndmask_b32 v32, v146, v147, s[56:57]
    v_subrev_u32 v145, 1, v144
    v_cmp_gt_u32 vcc, 8, v145
    v_mfma_f32_16x16x32_bf16 v[72:75], v[44:47], a[88:91], v[72:75]
    s_add_u32 s40, s40, s87
    v_cmp_gt_i32 s[56:57], 0, v145
    v_cndmask_b32 v37, v146, v143, vcc
    v_mfma_f32_16x16x32_bf16 v[132:135], v[44:47], a[240:243], v[132:135]
    s_waitcnt vmcnt(17) lgkmcnt(0)
    s_barrier
    ds_read_b128 a[96:99], v6 offset:8192
    ds_read_b128 a[100:103], v6 offset:9216
    v_mfma_f32_16x16x32_bf16 v[80:83], v[48:51], a[88:91], v[80:83]
    s_add_u32 m0, s39, 0x1000
    ds_read_b64_tr_b16 v[40:41], v11 offset:24576
    ds_read_b64_tr_b16 v[42:43], v11 offset:25344
    v_cndmask_b32 v33, v146, v147, s[56:57]
    v_mfma_f32_16x16x32_bf16 v[84:87], v[48:51], a[92:95], v[84:87]
    ds_read_b64_tr_b16 v[44:45], v12 offset:24576
    ds_read_b64_tr_b16 v[46:47], v12 offset:25344
    buffer_load_dwordx4 v4, s[4:7], s86 offen lds
    v_mfma_f32_16x16x32_bf16 v[92:95], v[52:55], a[92:95], v[92:95]
    s_nop 0
    ds_read_b64_tr_b16 v[48:49], v13 offset:24576
    ds_read_b64_tr_b16 v[50:51], v13 offset:25344
    v_mfma_f32_16x16x32_bf16 v[88:91], v[52:55], a[88:91], v[88:91]
    ds_read_b64_tr_b16 v[52:53], v14 offset:24576
    ds_read_b64_tr_b16 v[54:55], v14 offset:25344
    v_subrev_u32 v145, 2, v144
    v_mfma_f32_16x16x32_bf16 v[96:99], v[56:59], a[88:91], v[96:99]
    buffer_load_dwordx4 v5, s[4:7], s86 offen offset:1024 lds
    v_mfma_f32_16x16x32_bf16 v[100:103], v[56:59], a[92:95], v[100:103]
    ds_read_b64_tr_b16 v[56:57], v15 offset:24576
    ds_read_b64_tr_b16 v[58:59], v15 offset:25344
    v_cmp_gt_u32 vcc, 8, v145
    v_mfma_f32_16x16x32_bf16 v[108:111], v[60:63], a[92:95], v[108:111]
    v_cmp_gt_i32 s[56:57], 0, v145
    v_cndmask_b32 v38, v146, v143, vcc
    v_mfma_f32_16x16x32_bf16 v[104:107], v[60:63], a[88:91], v[104:107]
    s_waitcnt lgkmcnt(6)
    ds_read_b64_tr_b16 v[60:61], v16 offset:24576
    ds_read_b64_tr_b16 v[62:63], v16 offset:25344
    v_mfma_f32_16x16x32_bf16 v[64:67], v[40:43], a[96:99], v[64:67]
    ds_read_b128 a[104:107], v7 offset:8192
    ds_read_b128 a[108:111], v7 offset:9216
    v_cndmask_b32 v34, v146, v147, s[56:57]
    v_mfma_f32_16x16x32_bf16 v[68:71], v[40:43], a[100:103], v[68:71]
    buffer_load_dwordx4 v28, s[4:7], s86 offen offset:2048 lds
    v_mfma_f32_16x16x32_bf16 v[128:131], v[40:43], a[240:243], v[128:131]
    s_nop 0
    ds_read_b64_tr_b16 v[40:41], v11 offset:30720
    ds_read_b64_tr_b16 v[42:43], v11 offset:31488
    v_mfma_f32_16x16x32_bf16 v[76:79], v[44:47], a[100:103], v[76:79]
    buffer_load_dwordx4 v29, s[4:7], s86 offen offset:3072 lds
    v_subrev_u32 v145, 3, v144
    v_mfma_f32_16x16x32_bf16 v[72:75], v[44:47], a[96:99], v[72:75]
    s_add_u32 m0, s41, 0x3000
    v_cmp_gt_u32 vcc, 8, v145
    v_cmp_gt_i32 s[56:57], 0, v145
    v_mfma_f32_16x16x32_bf16 v[132:135], v[44:47], a[240:243], v[132:135]
    s_waitcnt lgkmcnt(4)
    ds_read_b64_tr_b16 v[44:45], v12 offset:30720
    ds_read_b64_tr_b16 v[46:47], v12 offset:31488
    v_cndmask_b32 v39, v146, v143, vcc
    v_mfma_f32_16x16x32_bf16 v[80:83], v[48:51], a[96:99], v[80:83]
    v_cndmask_b32 v35, v146, v147, s[56:57]
    v_mov_b32 v144, 0x27400
    v_mfma_f32_16x16x32_bf16 v[84:87], v[48:51], a[100:103], v[84:87]
    s_nop 0
    ds_read_b64_tr_b16 v[48:49], v13 offset:30720
    ds_read_b64_tr_b16 v[50:51], v13 offset:31488
    v_mfma_f32_16x16x32_bf16 v[92:95], v[52:55], a[100:103], v[92:95]
    buffer_load_dwordx4 v8, s[16:19], s40 offen lds
    v_mov_b32 v146, 0
    v_mfma_f32_16x16x32_bf16 v[88:91], v[52:55], a[96:99], v[88:91]
    s_nop 0
    ds_read_b64_tr_b16 v[52:53], v14 offset:30720
    ds_read_b64_tr_b16 v[54:55], v14 offset:31488
    v_mfma_f32_16x16x32_bf16 v[96:99], v[56:59], a[96:99], v[96:99]
    buffer_load_dwordx4 v9, s[16:19], s40 offen offset:1024 lds
    v_mfma_f32_16x16x32_bf16 v[100:103], v[56:59], a[100:103], v[100:103]
    ds_read_b64_tr_b16 v[56:57], v15 offset:30720
    ds_read_b64_tr_b16 v[58:59], v15 offset:31488
    v_mov_b32 v147, 0
    v_mfma_f32_16x16x32_bf16 v[108:111], v[60:63], a[100:103], v[108:111]
    ds_write_b64 v144, v[146:147]
    v_mfma_f32_16x16x32_bf16 v[104:107], v[60:63], a[96:99], v[104:107]
    s_waitcnt lgkmcnt(5)
    ds_read_b64_tr_b16 v[60:61], v16 offset:30720
    ds_read_b64_tr_b16 v[62:63], v16 offset:31488
    v_mfma_f32_16x16x32_bf16 v[64:67], v[40:43], a[104:107], v[64:67]
    buffer_load_dwordx4 v10, s[16:19], s40 offen offset:2048 lds
    v_mfma_f32_16x16x32_bf16 v[68:71], v[40:43], a[108:111], v[68:71]
    v_mfma_f32_16x16x32_bf16 v[128:131], v[40:43], a[240:243], v[128:131]
    v_mfma_f32_16x16x32_bf16 v[76:79], v[44:47], a[108:111], v[76:79]
    v_mfma_f32_16x16x32_bf16 v[72:75], v[44:47], a[104:107], v[72:75]
    v_mfma_f32_16x16x32_bf16 v[132:135], v[44:47], a[240:243], v[132:135]
    s_waitcnt vmcnt(14) lgkmcnt(0)
    s_barrier
    buffer_load_dwordx4 v[248:251], v24, s[28:31], 0 offen sc1
    v_mfma_f32_16x16x32_bf16 v[80:83], v[48:51], a[104:107], v[80:83]
    ds_read_b128 a[112:115], v6 offset:12288
    ds_read_b128 a[116:119], v6 offset:13312
    buffer_load_dwordx4 v[112:115], v126, s[28:31], 0 offen sc1
    v_mfma_f32_16x16x32_bf16 v[84:87], v[48:51], a[108:111], v[84:87]
    s_nop 0
    ds_read_b64_tr_b16 v[40:41], v11 offset:36864
    ds_read_b64_tr_b16 v[42:43], v11 offset:37632
    v_mfma_f32_16x16x32_bf16 v[92:95], v[52:55], a[108:111], v[92:95]
    s_nop 0
    ds_read_b64_tr_b16 v[44:45], v12 offset:36864
    ds_read_b64_tr_b16 v[46:47], v12 offset:37632
    v_mfma_f32_16x16x32_bf16 v[88:91], v[52:55], a[104:107], v[88:91]
    ds_read_b64_tr_b16 v[48:49], v13 offset:36864
    ds_read_b64_tr_b16 v[50:51], v13 offset:37632
    ds_read_b64_tr_b16 v[188:189], v159
    v_mfma_f32_16x16x32_bf16 v[96:99], v[56:59], a[104:107], v[96:99]
    ds_read_b64_tr_b16 v[52:53], v14 offset:36864
    ds_read_b64_tr_b16 v[54:55], v14 offset:37632
    buffer_load_dwordx2 v[116:117], v127, s[28:31], 0 offen sc1
    v_mfma_f32_16x16x32_bf16 v[100:103], v[56:59], a[108:111], v[100:103]
    s_nop 0
    ds_read_b64_tr_b16 v[56:57], v15 offset:36864
    ds_read_b64_tr_b16 v[58:59], v15 offset:37632
    v_mfma_f32_16x16x32_bf16 v[108:111], v[60:63], a[108:111], v[108:111]
    s_nop 0
    ds_read_b64_tr_b16 v[190:191], v159 offset:512
    ds_read_b64_tr_b16 v[192:193], v159 offset:1024
    v_mfma_f32_16x16x32_bf16 v[104:107], v[60:63], a[104:107], v[104:107]
    s_waitcnt lgkmcnt(11)
    ds_read_b64_tr_b16 v[60:61], v16 offset:36864
    ds_read_b64_tr_b16 v[62:63], v16 offset:37632
    ds_read_b64_tr_b16 v[194:195], v159 offset:1536
    v_mfma_f32_16x16x32_bf16 v[64:67], v[40:43], a[112:115], v[64:67]
    s_nop 0
    ds_read_b128 a[120:123], v7 offset:12288
    ds_read_b128 a[124:127], v7 offset:13312
    v_mfma_f32_16x16x32_bf16 v[68:71], v[40:43], a[116:119], v[68:71]
    s_nop 0
    ds_read_b64_tr_b16 v[196:197], v159 offset:2048
    ds_read_b64_tr_b16 v[198:199], v159 offset:2560
    v_mfma_f32_16x16x32_bf16 v[128:131], v[40:43], a[240:243], v[128:131]
    s_waitcnt lgkmcnt(11)
    ds_read_b64_tr_b16 v[40:41], v11 offset:43008
    ds_read_b64_tr_b16 v[42:43], v11 offset:43776
    v_mfma_f32_16x16x32_bf16 v[76:79], v[44:47], a[116:119], v[76:79]
    v_mfma_f32_16x16x32_bf16 v[72:75], v[44:47], a[112:115], v[72:75]
    s_waitcnt lgkmcnt(9)
    buffer_store_dwordx4 v[188:191], v162, s[28:31], s61 offen sc1
    v_mfma_f32_16x16x32_bf16 v[132:135], v[44:47], a[240:243], v[132:135]
    s_nop 0
    ds_read_b64_tr_b16 v[44:45], v12 offset:43008
    ds_read_b64_tr_b16 v[46:47], v12 offset:43776
    v_mfma_f32_16x16x32_bf16 v[80:83], v[48:51], a[112:115], v[80:83]
    v_mfma_f32_16x16x32_bf16 v[84:87], v[48:51], a[116:119], v[84:87]
    s_nop 0
    ds_read_b64_tr_b16 v[48:49], v13 offset:43008
    ds_read_b64_tr_b16 v[50:51], v13 offset:43776
    v_mfma_f32_16x16x32_bf16 v[92:95], v[52:55], a[116:119], v[92:95]
    s_waitcnt lgkmcnt(4)
    buffer_store_dwordx4 v[192:195], v163, s[28:31], s62 offen sc1
    v_mfma_f32_16x16x32_bf16 v[88:91], v[52:55], a[112:115], v[88:91]
    s_nop 0
    ds_read_b64_tr_b16 v[52:53], v14 offset:43008
    ds_read_b64_tr_b16 v[54:55], v14 offset:43776
    v_mfma_f32_16x16x32_bf16 v[96:99], v[56:59], a[112:115], v[96:99]
    v_mfma_f32_16x16x32_bf16 v[100:103], v[56:59], a[116:119], v[100:103]
    s_nop 0
    ds_read_b64_tr_b16 v[56:57], v15 offset:43008
    ds_read_b64_tr_b16 v[58:59], v15 offset:43776
    v_mfma_f32_16x16x32_bf16 v[108:111], v[60:63], a[116:119], v[108:111]
    v_mfma_f32_16x16x32_bf16 v[104:107], v[60:63], a[112:115], v[104:107]
    s_nop 0
    ds_read_b64_tr_b16 v[60:61], v16 offset:43008
    ds_read_b64_tr_b16 v[62:63], v16 offset:43776
    v_mfma_f32_16x16x32_bf16 v[64:67], v[40:43], a[120:123], v[64:67]
    buffer_store_dwordx4 v[196:199], v164, s[28:31], s63 offen sc1
    v_mfma_f32_16x16x32_bf16 v[68:71], v[40:43], a[124:127], v[68:71]
    v_mfma_f32_16x16x32_bf16 v[128:131], v[40:43], a[240:243], v[128:131]
    s_waitcnt lgkmcnt(4)
    v_mfma_f32_16x16x32_bf16 v[76:79], v[44:47], a[124:127], v[76:79]
    v_mfma_f32_16x16x32_bf16 v[72:75], v[44:47], a[120:123], v[72:75]
    v_mfma_f32_16x16x32_bf16 v[132:135], v[44:47], a[240:243], v[132:135]
    s_waitcnt vmcnt(5)
    v_xor_b32 v248, s81, v248
    v_xor_b32 v249, s81, v249
    v_xor_b32 v250, s81, v250
    v_xor_b32 v251, s81, v251
    v_or3_b32 v248, v248, v249, v250
    v_or_b32 v248, v248, v251
    v_cmp_ne_u32 vcc, 0, v248
    s_nop 0
    s_cbranch_vccnz L_slow_f1
L_ok_f1:
    s_waitcnt lgkmcnt(0)
    s_barrier
    v_mfma_f32_16x16x32_bf16 v[80:83], v[48:51], a[120:123], v[80:83]
    s_add_u32 m0, s39, 0x2000
    ds_read_b128 a[128:131], v6
    ds_read_b128 a[132:135], v6 offset:1024
    v_mfma_f32_16x16x32_bf16 v[84:87], v[48:51], a[124:127], v[84:87]
    ds_read_b64_tr_b16 v[40:41], v11
    ds_read_b64_tr_b16 v[42:43], v11 offset:768
    buffer_load_dwordx4 v2, s[28:31], s42 offen sc1 lds
    v_mfma_f32_16x16x32_bf16 v[92:95], v[52:55], a[124:127], v[92:95]
    s_nop 0
    ds_read_b64_tr_b16 v[44:45], v12
    ds_read_b64_tr_b16 v[46:47], v12 offset:768
    v_mfma_f32_16x16x32_bf16 v[88:91], v[52:55], a[120:123], v[88:91]
    ds_read_b64_tr_b16 v[48:49], v13
    ds_read_b64_tr_b16 v[50:51], v13 offset:768
    buffer_load_dwordx4 v2, s[28:31], s42 offen offset:1024 sc1 lds
    v_mfma_f32_16x16x32_bf16 v[96:99], v[56:59], a[120:123], v[96:99]
    s_nop 0
    ds_read_b64_tr_b16 v[52:53], v14
    ds_read_b64_tr_b16 v[54:55], v14 offset:768
    v_mfma_f32_16x16x32_bf16 v[100:103], v[56:59], a[124:127], v[100:103]
    s_nop 0
    ds_read_b64_tr_b16 v[56:57], v15
    ds_read_b64_tr_b16 v[58:59], v15 offset:768
    v_mfma_f32_16x16x32_bf16 v[108:111], v[60:63], a[124:127], v[108:111]
    buffer_load_dwordx4 v2, s[28:31], s42 offen offset:2048 sc1 lds
    v_mfma_f32_16x16x32_bf16 v[104:107], v[60:63], a[120:123], v[104:107]
    s_waitcnt lgkmcnt(8)
    ds_read_b64_tr_b16 v[60:61], v16
    ds_read_b64_tr_b16 v[62:63], v16 offset:768
    v_mfma_f32_16x16x32_bf16 v[64:67], v[40:43], a[128:131], v[64:67]
    s_nop 0
    ds_read_b128 a[136:139], v7
    ds_read_b128 a[140:143], v7 offset:1024
    v_mfma_f32_16x16x32_bf16 v[68:71], v[40:43], a[132:135], v[68:71]
    buffer_load_dwordx4 v2, s[28:31], s42 offen offset:3072 sc1 lds
    v_mfma_f32_16x16x32_bf16 v[128:131], v[40:43], a[240:243], v[128:131]
    s_add_u32 s88, s88, 4
    ds_read_b64_tr_b16 v[40:41], v11 offset:6144
    ds_read_b64_tr_b16 v[42:43], v11 offset:6912
    s_cmp_ge_u32 s88, 20
    s_cselect_b32 s42, 20, 0
    s_sub_u32 s88, s88, s42
    s_waitcnt lgkmcnt(8)
    v_mfma_f32_16x16x32_bf16 v[76:79], v[44:47], a[132:135], v[76:79]
    s_lshl_b32 s42, s88, 12
    s_add_u32 s42, s42, s89
    s_add_u32 m0, s39, 0x3000
    v_mfma_f32_16x16x32_bf16 v[72:75], v[44:47], a[128:131], v[72:75]
    buffer_load_dwordx4 v2, s[28:31], s42 offen sc1 lds
    v_mfma_f32_16x16x32_bf16 v[132:135], v[44:47], a[240:243], v[132:135]
    s_nop 0
    ds_read_b64_tr_b16 v[44:45], v12 offset:6144
    ds_read_b64_tr_b16 v[46:47], v12 offset:6912
    v_mfma_f32_16x16x32_bf16 v[80:83], v[48:51], a[128:131], v[80:83]
    buffer_load_dwordx4 v2, s[28:31], s42 offen offset:1024 sc1 lds
    v_mfma_f32_16x16x32_bf16 v[84:87], v[48:51], a[132:135], v[84:87]
    s_nop 0
    ds_read_b64_tr_b16 v[48:49], v13 offset:6144
    ds_read_b64_tr_b16 v[50:51], v13 offset:6912
    v_mfma_f32_16x16x32_bf16 v[92:95], v[52:55], a[132:135], v[92:95]
    v_mfma_f32_16x16x32_bf16 v[88:91], v[52:55], a[128:131], v[88:91]
    s_waitcnt lgkmcnt(4)
    ds_read_b64_tr_b16 v[52:53], v14 offset:6144
    ds_read_b64_tr_b16 v[54:55], v14 offset:6912
    v_mfma_f32_16x16x32_bf16 v[96:99], v[56:59], a[128:131], v[96:99]
    buffer_load_dwordx4 v2, s[28:31], s42 offen offset:2048 sc1 lds
    v_mfma_f32_16x16x32_bf16 v[100:103], v[56:59], a[132:135], v[100:103]
    s_nop 0
    ds_read_b64_tr_b16 v[56:57], v15 offset:6144
    ds_read_b64_tr_b16 v[58:59], v15 offset:6912
    v_mfma_f32_16x16x32_bf16 v[108:111], v[60:63], a[132:135], v[108:111]
    buffer_load_dwordx4 v2, s[28:31], s42 offen offset:3072 sc1 lds
    v_mfma_f32_16x16x32_bf16 v[104:107], v[60:63], a[128:131], v[104:107]
    s_add_u32 s88, s88, 4
    ds_read_b64_tr_b16 v[60:61], v16 offset:6144
    ds_read_b64_tr_b16 v[62:63], v16 offset:6912
    v_mfma_f32_16x16x32_bf16 v[64:67], v[40:43], a[136:139], v[64:67]
    s_cmp_ge_u32 s88, 20
    s_cselect_b32 s42, 20, 0
    v_mfma_f32_16x16x32_bf16 v[68:71], v[40:43], a[140:143], v[68:71]
    s_sub_u32 s88, s88, s42
    v_mfma_f32_16x16x32_bf16 v[128:131], v[40:43], a[240:243], v[128:131]
    s_waitcnt lgkmcnt(4)
    s_lshl_b32 s42, s88, 12
    v_mfma_f32_16x16x32_bf16 v[76:79], v[44:47], a[140:143], v[76:79]
    s_add_u32 s42, s42, s89
    v_mfma_f32_16x16x32_bf16 v[72:75], v[44:47], a[136:139], v[72:75]
    v_mfma_f32_16x16x32_bf16 v[132:135], v[44:47], a[240:243], v[132:135]
    s_waitcnt lgkmcnt(0)
    s_barrier
    ds_read_b128 a[144:147], v6 offset:4096
    ds_read_b128 a[148:151], v6 offset:5120
    v_mfma_f32_16x16x32_bf16 v[80:83], v[48:51], a[136:139], v[80:83]
    s_add_u32 m0, s39, 0
    ds_read_b64_tr_b16 v[40:41], v11 offset:12288
    ds_read_b64_tr_b16 v[42:43], v11 offset:13056
    v_mfma_f32_16x16x32_bf16 v[84:87], v[48:51], a[140:143], v[84:87]
    s_mul_i32 s97, s35, 0x14000
    ds_read_b64_tr_b16 v[44:45], v12 offset:12288
    ds_read_b64_tr_b16 v[46:47], v12 offset:13056
    v_mfma_f32_16x16x32_bf16 v[92:95], v[52:55], a[140:143], v[92:95]
    s_mul_i32 s95, s36, 0xa0
    ds_read_b64_tr_b16 v[48:49], v13 offset:12288
    ds_read_b64_tr_b16 v[50:51], v13 offset:13056
    s_add_u32 s97, s97, s95
    v_mfma_f32_16x16x32_bf16 v[88:91], v[52:55], a[136:139], v[88:91]
    s_nop 0
    ds_read_b64_tr_b16 v[52:53], v14 offset:12288
    ds_read_b64_tr_b16 v[54:55], v14 offset:13056
    v_mfma_f32_16x16x32_bf16 v[96:99], v[56:59], a[136:139], v[96:99]
    buffer_load_dwordx4 v2, s[28:31], s42 offen sc1 lds
    v_mfma_f32_16x16x32_bf16 v[100:103], v[56:59], a[140:143], v[100:103]
    ds_read_b64_tr_b16 v[56:57], v15 offset:12288
    ds_read_b64_tr_b16 v[58:59], v15 offset:13056
    v_add_u32 v217, 0, v0
    v_mfma_f32_16x16x32_bf16 v[108:111], v[60:63], a[140:143], v[108:111]
    buffer_load_dwordx4 v2, s[28:31], s42 offen offset:1024 sc1 lds
    v_mfma_f32_16x16x32_bf16 v[104:107], v[60:63], a[136:139], v[104:107]
    s_waitcnt lgkmcnt(6)
    ds_read_b64_tr_b16 v[60:61], v16 offset:12288
    ds_read_b64_tr_b16 v[62:63], v16 offset:13056
    v_mul_u32_u24 v218, 0x667, v217
    v_mfma_f32_16x16x32_bf16 v[64:67], v[40:43], a[144:147], v[64:67]
    s_nop 0
    ds_read_b128 a[152:155], v7 offset:4096
    ds_read_b128 a[156:159], v7 offset:5120
    v_mfma_f32_16x16x32_bf16 v[68:71], v[40:43], a[148:151], v[68:71]
    v_lshrrev_b32 v218, 15, v218
    v_mul_u32_u24 v219, 20, v218
    v_mfma_f32_16x16x32_bf16 v[128:131], v[40:43], a[240:243], v[128:131]
    ds_read_b64_tr_b16 v[40:41], v11 offset:18432
    ds_read_b64_tr_b16 v[42:43], v11 offset:19200
    v_sub_u32 v219, v217, v219
    v_mfma_f32_16x16x32_bf16 v[76:79], v[44:47], a[148:151], v[76:79]
    v_mul_u32_u24 v216, 0x500, v218
    v_lshl_add_u32 v216, v219, 3, v216
    v_mfma_f32_16x16x32_bf16 v[72:75], v[44:47], a[144:147], v[72:75]
    buffer_load_dwordx4 v2, s[28:31], s42 offen offset:2048 sc1 lds
    v_mfma_f32_16x16x32_bf16 v[132:135], v[44:47], a[240:243], v[132:135]
    s_waitcnt lgkmcnt(4)
    ds_read_b64_tr_b16 v[44:45], v12 offset:18432
    ds_read_b64_tr_b16 v[46:47], v12 offset:19200
    v_mfma_f32_16x16x32_bf16 v[80:83], v[48:51], a[144:147], v[80:83]
    buffer_load_dwordx2 a[244:245], v216, s[4:7], s97 offen
    v_mfma_f32_16x16x32_bf16 v[84:87], v[48:51], a[148:151], v[84:87]
    ds_read_b64_tr_b16 v[48:49], v13 offset:18432
    ds_read_b64_tr_b16 v[50:51], v13 offset:19200
    v_add_u32 v217, 0x100, v0
    v_mfma_f32_16x16x32_bf16 v[92:95], v[52:55], a[148:151], v[92:95]
    v_mul_u32_u24 v218, 0x667, v217
    v_lshrrev_b32 v218, 15, v218
    v_mfma_f32_16x16x32_bf16 v[88:91], v[52:55], a[144:147], v[88:91]
    s_nop 0
    ds_read_b64_tr_b16 v[52:53], v14 offset:18432
    ds_read_b64_tr_b16 v[54:55], v14 offset:19200
    v_mfma_f32_16x16x32_bf16 v[96:99], v[56:59], a[144:147], v[96:99]
    buffer_load_dwordx4 v2, s[28:31], s42 offen offset:3072 sc1 lds
    v_mul_u32_u24 v219, 20, v218
    v_mfma_f32_16x16x32_bf16 v[100:103], v[56:59], a[148:151], v[100:103]
    s_add_u32 s88, s88, 4
    ds_read_b64_tr_b16 v[56:57], v15 offset:18432
    ds_read_b64_tr_b16 v[58:59], v15 offset:19200
    v_mfma_f32_16x16x32_bf16 v[108:111], v[60:63], a[148:151], v[108:111]
    s_cmp_ge_u32 s88, 20
    s_cselect_b32 s42, 20, 0
    v_sub_u32 v219, v217, v219
    v_mfma_f32_16x16x32_bf16 v[104:107], v[60:63], a[144:147], v[104:107]
    s_waitcnt lgkmcnt(4)
    s_sub_u32 s88, s88, s42
    ds_read_b64_tr_b16 v[60:61], v16 offset:18432
    ds_read_b64_tr_b16 v[62:63], v16 offset:19200
    v_mul_u32_u24 v216, 0x500, v218
    v_mfma_f32_16x16x32_bf16 v[64:67], v[40:43], a[152:155], v[64:67]
    s_lshl_b32 s42, s88, 12
    v_lshl_add_u32 v216, v219, 3, v216
    v_mfma_f32_16x16x32_bf16 v[68:71], v[40:43], a[156:159], v[68:71]
    s_add_u32 s42, s42, s89
    buffer_load_dwordx2 a[246:247], v216, s[4:7], s97 offen
    v_add_u32 v217, 0x200, v0
    v_mfma_f32_16x16x32_bf16 v[128:131], v[40:43], a[240:243], v[128:131]
    v_mul_u32_u24 v218, 0x667, v217
    v_lshrrev_b32 v218, 15, v218
    v_mfma_f32_16x16x32_bf16 v[76:79], v[44:47], a[156:159], v[76:79]
    v_mul_u32_u24 v219, 20, v218
    v_sub_u32 v219, v217, v219
    v_mfma_f32_16x16x32_bf16 v[72:75], v[44:47], a[152:155], v[72:75]
    v_mul_u32_u24 v216, 0x500, v218
    v_lshl_add_u32 v216, v219, 3, v216
    v_mfma_f32_16x16x32_bf16 v[132:135], v[44:47], a[240:243], v[132:135]
    s_waitcnt vmcnt(10) lgkmcnt(0)
    s_barrier
    buffer_store_dword v27, v25, s[28:31], 0 offen sc1
    v_mfma_f32_16x16x32_bf16 v[80:83], v[48:51], a[152:155], v[80:83]
    s_add_u32 m0, s39, 0x1000
    ds_read_b128 v[40:43], v19 offset:8192
    ds_read_b128 v[44:47], v20 offset:8192
    v_mfma_f32_16x16x32_bf16 v[84:87], v[48:51], a[156:159], v[84:87]
    ds_read_b128 v[48:51], v21 offset:8192
    v_xor_b32 v118, v27, v113
    v_mfma_f32_16x16x32_bf16 v[92:95], v[52:55], a[156:159], v[92:95]
    buffer_load_dwordx4 v2, s[28:31], s42 offen sc1 lds
    v_mfma_f32_16x16x32_bf16 v[88:91], v[52:55], a[152:155], v[88:91]
    ds_read_b128 v[52:55], v22 offset:8192
    v_xor_b32 v119, v27, v115
    v_mfma_f32_16x16x32_bf16 v[96:99], v[56:59], a[152:155], v[96:99]
    v_xor_b32 v117, v27, v117
    v_or3_b32 v118, v118, v119, v117
    v_mfma_f32_16x16x32_bf16 v[100:103], v[56:59], a[156:159], v[100:103]
    ds_read_b128 v[56:59], v17
    v_cmp_ne_u32 vcc, 0, v118
    s_nop 0
    s_cbranch_vccnz L_slow_st
L_ok_st:
    v_mfma_f32_16x16x32_bf16 v[108:111], v[60:63], a[156:159], v[108:111]
    buffer_load_dwordx2 a[248:249], v216, s[4:7], s97 offen
    v_add_u32 v217, 0x300, v0
    v_mfma_f32_16x16x32_bf16 v[104:107], v[60:63], a[152:155], v[104:107]
    s_waitcnt lgkmcnt(2)
    v_mul_u32_u24 v218, 0x667, v217
    v_lshrrev_b32 v218, 15, v218
    v_mfma_f32_16x16x32_bf16 v[136:139], v[40:43], a[0:3], 0
    v_mul_u32_u24 v219, 20, v218
    v_sub_u32 v219, v217, v219
    v_mfma_f32_16x16x32_bf16 v[140:143], v[40:43], a[4:7], 0
    s_waitcnt lgkmcnt(0)
    buffer_load_dwordx4 v2, s[28:31], s42 offen offset:1024 sc1 lds
    v_mul_u32_u24 v216, 0x500, v218
    v_mfma_f32_16x16x32_bf16 v[168:171], v[40:43], v[56:59], 0
    s_nop 0
    ds_read_b128 v[40:43], v19 offset:24576
    ds_read_b128 v[56:59], v18
    v_mfma_f32_16x16x32_bf16 v[148:151], v[44:47], a[4:7], 0
    v_lshl_add_u32 v216, v219, 3, v216
    v_mfma_f32_16x16x32_bf16 v[144:147], v[44:47], a[0:3], 0
    s_lshl_b32 s56, s68, 7
    ds_read_b128 v[44:47], v20 offset:24576
    v_lshrrev_b32 v172, 4, v1
    v_mfma_f32_16x16x32_bf16 v[152:155], v[48:51], a[0:3], 0
    s_add_u32 s56, s56, 0x27000
    v_lshl_add_u32 v172, v172, 4, s56
    v_mfma_f32_16x16x32_bf16 v[156:159], v[48:51], a[4:7], 0
    ds_read_b128 v[48:51], v21 offset:24576
    buffer_load_dwordx2 a[250:251], v216, s[4:7], s97 offen
    v_mfma_f32_16x16x32_bf16 v[164:167], v[52:55], a[4:7], 0
    s_mov_b64 exec, s[70:71]
    ds_write_b128 v172, v[128:131]
    s_mov_b64 exec, -1
    v_mfma_f32_16x16x32_bf16 v[160:163], v[52:55], a[0:3], 0
    s_waitcnt lgkmcnt(3)
    ds_read_b128 v[52:55], v22 offset:24576
    v_add_u32 v217, 0x400, v0
    v_mfma_f32_16x16x32_bf16 v[136:139], v[40:43], a[8:11], v[136:139]
    s_mov_b64 exec, s[70:71]
    ds_write_b128 v172, v[132:135] offset:64
    s_mov_b64 exec, -1
    v_mfma_f32_16x16x32_bf16 v[140:143], v[40:43], a[12:15], v[140:143]
    buffer_load_dwordx4 v2, s[28:31], s42 offen offset:2048 sc1 lds
    v_mfma_f32_16x16x32_bf16 v[168:171], v[40:43], v[56:59], v[168:171]
    s_waitcnt lgkmcnt(4)
    ds_read_b128 v[40:43], v19 offset:40960
    ds_read_b128 v[56:59], v17 offset:2048
    v_mul_u32_u24 v218, 0x667, v217
    v_mfma_f32_16x16x32_bf16 v[148:151], v[44:47], a[12:15], v[148:151]
    v_and_b32 v30, 0xffff0000, v112
    v_lshlrev_b32 v28, 16, v112
    v_mfma_f32_16x16x32_bf16 v[144:147], v[44:47], a[8:11], v[144:147]
    s_waitcnt lgkmcnt(4)
    ds_read_b128 v[44:47], v20 offset:40960
    v_lshrrev_b32 v218, 15, v218
    v_mfma_f32_16x16x32_bf16 v[152:155], v[48:51], a[8:11], v[152:155]
    v_rcp_f32 v30, v30
    v_mul_u32_u24 v219, 20, v218
    v_mfma_f32_16x16x32_bf16 v[156:159], v[48:51], a[12:15], v[156:159]
    s_waitcnt lgkmcnt(3)
    ds_read_b128 v[48:51], v21 offset:40960
    v_and_b32 v31, 0xffff0000, v114
    v_mfma_f32_16x16x32_bf16 v[164:167], v[52:55], a[12:15], v[164:167]
    v_lshlrev_b32 v29, 16, v114
    v_sub_u32 v219, v217, v219
    v_mfma_f32_16x16x32_bf16 v[160:163], v[52:55], a[8:11], v[160:163]
    s_waitcnt lgkmcnt(2)
    ds_read_b128 v[52:55], v22 offset:40960
    v_mul_u32_u24 v216, 0x500, v218
    v_lshl_add_u32 v216, v219, 3, v216
    v_mfma_f32_16x16x32_bf16 v[136:139], v[40:43], a[16:19], v[136:139]
    buffer_load_dwordx4 v2, s[28:31], s42 offen offset:3072 sc1 lds
    v_mfma_f32_16x16x32_bf16 v[140:143], v[40:43], a[20:23], v[140:143]
    s_add_u32 s88, s88, 4
    v_rcp_f32 v31, v31
    v_mfma_f32_16x16x32_bf16 v[168:171], v[40:43], v[56:59], v[168:171]
    s_waitcnt lgkmcnt(2)
    s_cmp_ge_u32 s88, 20
    s_cselect_b32 s42, 20, 0
    ds_read_b128 v[40:43], v19 offset:57344
    ds_read_b128 v[56:59], v18 offset:2048
    v_mfma_f32_16x16x32_bf16 v[148:151], v[44:47], a[20:23], v[148:151]
    s_sub_u32 s88, s88, s42
    v_and_b32 v62, 0xffff0000, v116
    v_lshlrev_b32 v61, 16, v116
    v_mfma_f32_16x16x32_bf16 v[144:147], v[44:47], a[16:19], v[144:147]
    s_waitcnt lgkmcnt(3)
    s_lshl_b32 s42, s88, 12
    ds_read_b128 v[44:47], v20 offset:57344
    buffer_load_dwordx2 a[252:253], v216, s[4:7], s97 offen
    v_mfma_f32_16x16x32_bf16 v[152:155], v[48:51], a[16:19], v[152:155]
    s_add_u32 s42, s42, s89
    v_rcp_f32 v62, v62
    v_mfma_f32_16x16x32_bf16 v[156:159], v[48:51], a[20:23], v[156:159]
    s_waitcnt lgkmcnt(3)
    s_cmp_eq_u32 s32, 0
    s_cselect_b32 s96, 0, 0x70000000
    ds_read_b128 v[48:51], v21 offset:57344
    v_mfma_f32_16x16x32_bf16 v[164:167], v[52:55], a[20:23], v[164:167]
    s_add_u32 s96, s96, 0x1400
    v_lshl_add_u32 v24, v1, 4, s96
    v_mfma_f32_16x16x32_bf16 v[160:163], v[52:55], a[16:19], v[160:163]
    s_waitcnt lgkmcnt(2)
    ds_read_b128 v[52:55], v22 offset:57344
    v_mfma_f32_16x16x32_bf16 v[136:139], v[40:43], a[24:27], v[136:139]
    v_mfma_f32_16x16x32_bf16 v[140:143], v[40:43], a[28:31], v[140:143]
    v_mfma_f32_16x16x32_bf16 v[168:171], v[40:43], v[56:59], v[168:171]
    s_waitcnt lgkmcnt(2)
    v_mfma_f32_16x16x32_bf16 v[148:151], v[44:47], a[28:31], v[148:151]
    v_mfma_f32_16x16x32_bf16 v[144:147], v[44:47], a[24:27], v[144:147]
    s_waitcnt vmcnt(14) lgkmcnt(0)
    s_barrier
    ds_read_b128 v[40:43], v19 offset:12288
    ds_read_b128 v[56:59], v17 offset:4096
    v_mfma_f32_16x16x32_bf16 v[152:155], v[48:51], a[24:27], v[152:155]
    s_add_u32 m0, s39, 0x2000
    ds_read_b128 v[44:47], v20 offset:12288
    v_lshrrev_b32 v112, 4, v1
    v_lshlrev_b32 v112, 4, v112
    v_mfma_f32_16x16x32_bf16 v[156:159], v[48:51], a[28:31], v[156:159]
    s_add_u32 s56, s68, 0
    ds_read_b128 v[48:51], v21 offset:12288
    s_cmp_ge_u32 s56, 3
    s_cselect_b32 s57, 3, 0
    v_mfma_f32_16x16x32_bf16 v[164:167], v[52:55], a[28:31], v[164:167]
    s_sub_u32 s56, s56, s57
    buffer_load_dwordx4 v2, s[28:31], s42 offen sc1 lds
    s_lshl_b32 s56, s56, 7
    v_mfma_f32_16x16x32_bf16 v[160:163], v[52:55], a[24:27], v[160:163]
    s_waitcnt lgkmcnt(3)
    s_add_u32 s56, s56, 0x27000
    ds_read_b128 v[52:55], v22 offset:12288
    v_add_u32 v113, s56, v112
    v_mfma_f32_16x16x32_bf16 v[136:139], v[40:43], a[32:35], v[136:139]
    s_add_u32 s56, s68, 1
    ds_read_b128 v[172:175], v113
    ds_read_b128 v[176:179], v113 offset:64
    v_mfma_f32_16x16x32_bf16 v[140:143], v[40:43], a[36:39], v[140:143]
    s_waitcnt lgkmcnt(5)
    s_cmp_ge_u32 s56, 3
    s_cselect_b32 s57, 3, 0
    s_sub_u32 s56, s56, s57
    s_lshl_b32 s56, s56, 7
    v_mfma_f32_16x16x32_bf16 v[168:171], v[40:43], v[56:59], v[168:171]
    s_waitcnt lgkmcnt(4)
    s_add_u32 s56, s56, 0x27000
    ds_read_b128 v[40:43], v19 offset:28672
    ds_read_b128 v[56:59], v18 offset:4096
    v_add_u32 v113, s56, v112
    v_mfma_f32_16x16x32_bf16 v[148:151], v[44:47], a[36:39], v[148:151]
    s_add_u32 s56, s68, 2
    ds_read_b128 v[180:183], v113
    ds_read_b128 v[184:187], v113 offset:64
    s_cmp_ge_u32 s56, 3
    s_cselect_b32 s57, 3, 0
    v_mfma_f32_16x16x32_bf16 v[144:147], v[44:47], a[32:35], v[144:147]
    s_waitcnt lgkmcnt(7)
    s_sub_u32 s56, s56, s57
    ds_read_b128 v[44:47], v20 offset:28672
    s_lshl_b32 s56, s56, 7
    s_add_u32 s56, s56, 0x27000
    v_mfma_f32_16x16x32_bf16 v[152:155], v[48:51], a[32:35], v[152:155]
    buffer_load_dwordx4 v2, s[28:31], s42 offen offset:1024 sc1 lds
    v_add_u32 v113, s56, v112
    v_mfma_f32_16x16x32_bf16 v[156:159], v[48:51], a[36:39], v[156:159]
    s_waitcnt lgkmcnt(5)
    ds_read_b128 v[48:51], v21 offset:28672
    ds_read_b128 v[188:191], v113
    ds_read_b128 v[192:195], v113 offset:64
    v_mfma_f32_16x16x32_bf16 v[164:167], v[52:55], a[36:39], v[164:167]
    v_mfma_f32_16x16x32_bf16 v[160:163], v[52:55], a[32:35], v[160:163]
    s_waitcnt lgkmcnt(6)
    ds_read_b128 v[52:55], v22 offset:28672
    v_fma_f32 v64, -v28, v172, v64
    v_fma_f32 v65, -v28, v173, v65
    v_mfma_f32_16x16x32_bf16 v[136:139], v[40:43], a[40:43], v[136:139]
    v_fma_f32 v66, -v28, v174, v66
    v_fma_f32 v67, -v28, v175, v67
    v_mul_f32 v64, v64, v30
    v_mfma_f32_16x16x32_bf16 v[140:143], v[40:43], a[44:47], v[140:143]
    v_mul_f32 v65, v65, v30
    v_mul_f32 v66, v66, v30
    v_mul_f32 v67, v67, v30
    v_mfma_f32_16x16x32_bf16 v[168:171], v[40:43], v[56:59], v[168:171]
    s_waitcnt lgkmcnt(4)
    ds_read_b128 v[40:43], v19 offset:45056
    ds_read_b128 v[56:59], v17 offset:6144
    v_cvt_pk_bf16_f32 v120, v64, v65
    v_cvt_pk_bf16_f32 v121, v66, v67
    v_mfma_f32_16x16x32_bf16 v[148:151], v[44:47], a[44:47], v[148:151]
    buffer_load_dwordx4 v2, s[28:31], s42 offen offset:2048 sc1 lds
    v_fma_f32 v72, -v28, v176, v72
    v_mfma_f32_16x16x32_bf16 v[144:147], v[44:47], a[40:43], v[144:147]
    s_waitcnt lgkmcnt(3)
    ds_read_b128 v[44:47], v20 offset:45056
    v_fma_f32 v73, -v28, v177, v73
    v_fma_f32 v74, -v28, v178, v74
    v_mfma_f32_16x16x32_bf16 v[152:155], v[48:51], a[40:43], v[152:155]
    v_fma_f32 v75, -v28, v179, v75
    v_mul_f32 v72, v72, v30
    v_mul_f32 v73, v73, v30
    v_mfma_f32_16x16x32_bf16 v[156:159], v[48:51], a[44:47], v[156:159]
    s_waitcnt lgkmcnt(3)
    ds_read_b128 v[48:51], v21 offset:45056
    v_mul_f32 v74, v74, v30
    v_mul_f32 v75, v75, v30
    v_mfma_f32_16x16x32_bf16 v[164:167], v[52:55], a[44:47], v[164:167]
    v_cvt_pk_bf16_f32 v122, v72, v73
    v_cvt_pk_bf16_f32 v123, v74, v75
    v_pk_max_i16 v120, v120, 0
    v_mfma_f32_16x16x32_bf16 v[160:163], v[52:55], a[40:43], v[160:163]
    s_waitcnt lgkmcnt(2)
    ds_read_b128 v[52:55], v22 offset:45056
    v_pk_max_i16 v121, v121, 0
    v_pk_max_i16 v122, v122, 0
    v_mfma_f32_16x16x32_bf16 v[136:139], v[40:43], a[48:51], v[136:139]
    v_pk_max_i16 v123, v123, 0
    v_mfma_f32_16x16x32_bf16 v[140:143], v[40:43], a[52:55], v[140:143]
    buffer_load_dwordx4 v2, s[28:31], s42 offen offset:3072 sc1 lds
    buffer_store_dwordx4 v[120:123], v2, s[28:31], s44 offen sc1
    v_mfma_f32_16x16x32_bf16 v[168:171], v[40:43], v[56:59], v[168:171]
    s_waitcnt lgkmcnt(2)
    s_add_u32 s88, s88, 4
    ds_read_b128 v[40:43], v19 offset:61440
    ds_read_b128 v[56:59], v18 offset:6144
    v_fma_f32 v68, -v29, v172, v68
    v_mfma_f32_16x16x32_bf16 v[148:151], v[44:47], a[52:55], v[148:151]
    s_cmp_ge_u32 s88, 20
    s_cselect_b32 s42, 20, 0
    v_fma_f32 v69, -v29, v173, v69
    v_fma_f32 v70, -v29, v174, v70
    v_mfma_f32_16x16x32_bf16 v[144:147], v[44:47], a[48:51], v[144:147]
    s_waitcnt lgkmcnt(3)
    s_sub_u32 s88, s88, s42
    ds_read_b128 v[44:47], v20 offset:61440
    v_fma_f32 v71, -v29, v175, v71
    v_mul_f32 v68, v68, v31
    v_mfma_f32_16x16x32_bf16 v[152:155], v[48:51], a[48:51], v[152:155]
    s_lshl_b32 s42, s88, 12
    v_mul_f32 v69, v69, v31
    v_mul_f32 v70, v70, v31
    v_mul_f32 v71, v71, v31
    v_mfma_f32_16x16x32_bf16 v[156:159], v[48:51], a[52:55], v[156:159]
    s_waitcnt lgkmcnt(3)
    s_add_u32 s42, s42, s89
    ds_read_b128 v[48:51], v21 offset:61440
    v_cvt_pk_bf16_f32 v124, v68, v69
    v_cvt_pk_bf16_f32 v125, v70, v71
    v_mfma_f32_16x16x32_bf16 v[164:167], v[52:55], a[52:55], v[164:167]
    s_add_u32 s42, s42, 0x14000
    v_fma_f32 v76, -v29, v176, v76
    v_fma_f32 v77, -v29, v177, v77
    v_fma_f32 v78, -v29, v178, v78
    v_mfma_f32_16x16x32_bf16 v[160:163], v[52:55], a[48:51], v[160:163]
    s_waitcnt lgkmcnt(2)
    ds_read_b128 v[52:55], v22 offset:61440
    v_fma_f32 v79, -v29, v179, v79
    v_mul_f32 v76, v76, v31
    v_mfma_f32_16x16x32_bf16 v[136:139], v[40:43], a[56:59], v[136:139]
    v_mul_f32 v77, v77, v31
    v_mul_f32 v78, v78, v31
    v_mul_f32 v79, v79, v31
    v_cvt_pk_bf16_f32 v126, v76, v77
    v_mfma_f32_16x16x32_bf16 v[140:143], v[40:43], a[60:63], v[140:143]
    v_cvt_pk_bf16_f32 v127, v78, v79
    v_pk_max_i16 v124, v124, 0
    v_pk_max_i16 v125, v125, 0
    v_mfma_f32_16x16x32_bf16 v[168:171], v[40:43], v[56:59], v[168:171]
    s_waitcnt lgkmcnt(2)
    v_pk_max_i16 v126, v126, 0
    v_pk_max_i16 v127, v127, 0
    v_mfma_f32_16x16x32_bf16 v[148:151], v[44:47], a[60:63], v[148:151]
    buffer_store_dwordx4 v[124:127], v2, s[28:31], s44 offen offset:1024 sc1
    v_fma_f32 v80, -v28, v180, v80
    v_mfma_f32_16x16x32_bf16 v[144:147], v[44:47], a[56:59], v[144:147]
    s_waitcnt vmcnt(15) lgkmcnt(0)
    s_barrier
    ds_read_b128 v[40:43], v19
    ds_read_b128 v[56:59], v17 offset:8192
    v_fma_f32 v81, -v28, v181, v81
    v_mfma_f32_16x16x32_bf16 v[152:155], v[48:51], a[56:59], v[152:155]
    s_add_u32 m0, s39, 0x3000
    ds_read_b128 v[44:47], v20
    v_fma_f32 v82, -v28, v182, v82
    v_fma_f32 v83, -v28, v183, v83
    v_mfma_f32_16x16x32_bf16 v[156:159], v[48:51], a[60:63], v[156:159]
    ds_read_b128 v[48:51], v21
    v_mul_f32 v80, v80, v30
    v_mul_f32 v81, v81, v30
    v_mfma_f32_16x16x32_bf16 v[164:167], v[52:55], a[60:63], v[164:167]
    buffer_load_dwordx4 v2, s[28:31], s42 offen sc1 lds
    v_mul_f32 v82, v82, v30
    v_mfma_f32_16x16x32_bf16 v[160:163], v[52:55], a[56:59], v[160:163]
    s_waitcnt lgkmcnt(3)
    ds_read_b128 v[52:55], v22
    v_mul_f32 v83, v83, v30
    v_cvt_pk_bf16_f32 v120, v80, v81
    v_cvt_pk_bf16_f32 v121, v82, v83
    v_mfma_f32_16x16x32_bf16 v[136:139], v[40:43], a[64:67], v[136:139]
    v_fma_f32 v88, -v28, v184, v88
    v_fma_f32 v89, -v28, v185, v89
    v_fma_f32 v90, -v28, v186, v90
    v_mfma_f32_16x16x32_bf16 v[140:143], v[40:43], a[68:71], v[140:143]
    s_waitcnt lgkmcnt(3)
    v_fma_f32 v91, -v28, v187, v91
    v_mul_f32 v88, v88, v30
    v_mul_f32 v89, v89, v30
    v_mfma_f32_16x16x32_bf16 v[168:171], v[40:43], v[56:59], v[168:171]
    s_waitcnt lgkmcnt(2)
    ds_read_b128 v[40:43], v19 offset:16384
    ds_read_b128 v[56:59], v18 offset:8192
    v_mul_f32 v90, v90, v30
    v_mfma_f32_16x16x32_bf16 v[148:151], v[44:47], a[68:71], v[148:151]
    v_mul_f32 v91, v91, v30
    v_cvt_pk_bf16_f32 v122, v88, v89
    v_cvt_pk_bf16_f32 v123, v90, v91
    v_mfma_f32_16x16x32_bf16 v[144:147], v[44:47], a[64:67], v[144:147]
    s_waitcnt lgkmcnt(3)
    ds_read_b128 v[44:47], v20 offset:16384
    v_pk_max_i16 v120, v120, 0
    v_pk_max_i16 v121, v121, 0
    v_mfma_f32_16x16x32_bf16 v[152:155], v[48:51], a[64:67], v[152:155]
    buffer_load_dwordx4 v2, s[28:31], s42 offen offset:1024 sc1 lds
    v_pk_max_i16 v122, v122, 0
    v_mfma_f32_16x16x32_bf16 v[156:159], v[48:51], a[68:71], v[156:159]
    s_waitcnt lgkmcnt(3)
    ds_read_b128 v[48:51], v21 offset:16384
    v_pk_max_i16 v123, v123, 0
    v_mfma_f32_16x16x32_bf16 v[164:167], v[52:55], a[68:71], v[164:167]
    buffer_store_dwordx4 v[120:123], v2, s[28:31], s45 offen sc1
    v_fma_f32 v84, -v29, v180, v84
    v_fma_f32 v85, -v29, v181, v85
    v_mfma_f32_16x16x32_bf16 v[160:163], v[52:55], a[64:67], v[160:163]
    s_waitcnt lgkmcnt(2)
    ds_read_b128 v[52:55], v22 offset:16384
    v_fma_f32 v86, -v29, v182, v86
    v_fma_f32 v87, -v29, v183, v87
    v_mfma_f32_16x16x32_bf16 v[136:139], v[40:43], a[72:75], v[136:139]
    v_mul_f32 v84, v84, v31
    v_mul_f32 v85, v85, v31
    v_mul_f32 v86, v86, v31
    v_mfma_f32_16x16x32_bf16 v[140:143], v[40:43], a[76:79], v[140:143]
    v_mul_f32 v87, v87, v31
    v_cvt_pk_bf16_f32 v124, v84, v85
    v_cvt_pk_bf16_f32 v125, v86, v87
    v_mfma_f32_16x16x32_bf16 v[168:171], v[40:43], v[56:59], v[168:171]
    s_waitcnt lgkmcnt(2)
    ds_read_b128 v[40:43], v19 offset:32768
    ds_read_b128 v[56:59], v17 offset:10240
    v_fma_f32 v92, -v29, v184, v92
    v_mfma_f32_16x16x32_bf16 v[148:151], v[44:47], a[76:79], v[148:151]
    buffer_load_dwordx4 v2, s[28:31], s42 offen offset:2048 sc1 lds
    v_fma_f32 v93, -v29, v185, v93
    v_mfma_f32_16x16x32_bf16 v[144:147], v[44:47], a[72:75], v[144:147]
    s_waitcnt lgkmcnt(3)
    ds_read_b128 v[44:47], v20 offset:32768
    v_fma_f32 v94, -v29, v186, v94
    v_fma_f32 v95, -v29, v187, v95
    v_mfma_f32_16x16x32_bf16 v[152:155], v[48:51], a[72:75], v[152:155]
    v_mul_f32 v92, v92, v31
    v_mul_f32 v93, v93, v31
    v_mul_f32 v94, v94, v31
    v_mfma_f32_16x16x32_bf16 v[156:159], v[48:51], a[76:79], v[156:159]
    s_waitcnt lgkmcnt(3)
    ds_read_b128 v[48:51], v21 offset:32768
    v_mul_f32 v95, v95, v31
    v_cvt_pk_bf16_f32 v126, v92, v93
    v_cvt_pk_bf16_f32 v127, v94, v95
    v_mfma_f32_16x16x32_bf16 v[164:167], v[52:55], a[76:79], v[164:167]
    v_pk_max_i16 v124, v124, 0
    v_pk_max_i16 v125, v125, 0
    v_pk_max_i16 v126, v126, 0
    v_mfma_f32_16x16x32_bf16 v[160:163], v[52:55], a[72:75], v[160:163]
    s_waitcnt lgkmcnt(2)
    ds_read_b128 v[52:55], v22 offset:32768
    v_pk_max_i16 v127, v127, 0
    v_mfma_f32_16x16x32_bf16 v[136:139], v[40:43], a[80:83], v[136:139]
    buffer_store_dwordx4 v[124:127], v2, s[28:31], s45 offen offset:1024 sc1
    v_fma_f32 v96, -v28, v188, v96
    v_mfma_f32_16x16x32_bf16 v[140:143], v[40:43], a[84:87], v[140:143]
    buffer_load_dwordx4 v2, s[28:31], s42 offen offset:3072 sc1 lds
    v_fma_f32 v97, -v28, v189, v97
    v_mfma_f32_16x16x32_bf16 v[168:171], v[40:43], v[56:59], v[168:171]
    s_waitcnt lgkmcnt(2)
    s_add_u32 s88, s88, 4
    ds_read_b128 v[40:43], v19 offset:49152
    ds_read_b128 v[56:59], v18 offset:10240
    v_fma_f32 v98, -v28, v190, v98
    v_mfma_f32_16x16x32_bf16 v[148:151], v[44:47], a[84:87], v[148:151]
    s_cmp_ge_u32 s88, 20
    s_cselect_b32 s42, 20, 0
    v_fma_f32 v99, -v28, v191, v99
    v_mul_f32 v96, v96, v30
    v_mfma_f32_16x16x32_bf16 v[144:147], v[44:47], a[80:83], v[144:147]
    s_waitcnt lgkmcnt(3)
    s_sub_u32 s88, s88, s42
    ds_read_b128 v[44:47], v20 offset:49152
    v_mul_f32 v97, v97, v30
    v_mul_f32 v98, v98, v30
    v_mfma_f32_16x16x32_bf16 v[152:155], v[48:51], a[80:83], v[152:155]
    s_lshl_b32 s42, s88, 12
    v_mul_f32 v99, v99, v30
    v_cvt_pk_bf16_f32 v120, v96, v97
    v_cvt_pk_bf16_f32 v121, v98, v99
    v_fma_f32 v104, -v28, v192, v104
    v_mfma_f32_16x16x32_bf16 v[156:159], v[48:51], a[84:87], v[156:159]
    s_waitcnt lgkmcnt(3)
    s_add_u32 s42, s42, s89
    ds_read_b128 v[48:51], v21 offset:49152
    v_fma_f32 v105, -v28, v193, v105
    v_fma_f32 v106, -v28, v194, v106
    v_mfma_f32_16x16x32_bf16 v[164:167], v[52:55], a[84:87], v[164:167]
    s_add_u32 s42, s42, 0x14000
    v_fma_f32 v107, -v28, v195, v107
    v_mul_f32 v104, v104, v30
    v_mul_f32 v105, v105, v30
    v_mfma_f32_16x16x32_bf16 v[160:163], v[52:55], a[80:83], v[160:163]
    s_waitcnt lgkmcnt(2)
    ds_read_b128 v[52:55], v22 offset:49152
    v_mul_f32 v106, v106, v30
    v_mul_f32 v107, v107, v30
    v_mfma_f32_16x16x32_bf16 v[136:139], v[40:43], a[88:91], v[136:139]
    v_cvt_pk_bf16_f32 v122, v104, v105
    v_cvt_pk_bf16_f32 v123, v106, v107
    v_pk_max_i16 v120, v120, 0
    v_mfma_f32_16x16x32_bf16 v[140:143], v[40:43], a[92:95], v[140:143]
    v_pk_max_i16 v121, v121, 0
    v_pk_max_i16 v122, v122, 0
    v_pk_max_i16 v123, v123, 0
    v_mfma_f32_16x16x32_bf16 v[168:171], v[40:43], v[56:59], v[168:171]
    s_waitcnt lgkmcnt(2)
    buffer_store_dwordx4 v[120:123], v2, s[28:31], s46 offen sc1
    v_fma_f32 v100, -v29, v188, v100
    v_mfma_f32_16x16x32_bf16 v[148:151], v[44:47], a[92:95], v[148:151]
    v_fma_f32 v101, -v29, v189, v101
    v_fma_f32 v102, -v29, v190, v102
    v_fma_f32 v103, -v29, v191, v103
    v_mfma_f32_16x16x32_bf16 v[144:147], v[44:47], a[88:91], v[144:147]
    s_waitcnt vmcnt(14) lgkmcnt(0)
    s_barrier
    ds_read_b128 v[40:43], v19 offset:4096
    ds_read_b128 v[56:59], v17 offset:12288
    v_mul_f32 v100, v100, v31
    v_mul_f32 v101, v101, v31
    v_mfma_f32_16x16x32_bf16 v[152:155], v[48:51], a[88:91], v[152:155]
    s_add_u32 m0, s39, 0
    ds_read_b128 v[44:47], v20 offset:4096
    v_mul_f32 v102, v102, v31
    v_mul_f32 v103, v103, v31
    v_mfma_f32_16x16x32_bf16 v[156:159], v[48:51], a[92:95], v[156:159]
    ds_read_b128 v[48:51], v21 offset:4096
    v_cvt_pk_bf16_f32 v124, v100, v101
    v_cvt_pk_bf16_f32 v125, v102, v103
    v_mfma_f32_16x16x32_bf16 v[164:167], v[52:55], a[92:95], v[164:167]
    buffer_load_dwordx4 v2, s[28:31], s42 offen sc1 lds
    v_fma_f32 v108, -v29, v192, v108
    v_mfma_f32_16x16x32_bf16 v[160:163], v[52:55], a[88:91], v[160:163]
    s_waitcnt lgkmcnt(3)
    ds_read_b128 v[52:55], v22 offset:4096
    v_fma_f32 v109, -v29, v193, v109
    v_fma_f32 v110, -v29, v194, v110
    v_mfma_f32_16x16x32_bf16 v[136:139], v[40:43], a[96:99], v[136:139]
    v_fma_f32 v111, -v29, v195, v111
    v_mul_f32 v108, v108, v31
    v_mul_f32 v109, v109, v31
    v_mfma_f32_16x16x32_bf16 v[140:143], v[40:43], a[100:103], v[140:143]
    s_waitcnt lgkmcnt(3)
    v_mul_f32 v110, v110, v31
    v_mul_f32 v111, v111, v31
    v_cvt_pk_bf16_f32 v126, v108, v109
    v_mfma_f32_16x16x32_bf16 v[168:171], v[40:43], v[56:59], v[168:171]
    s_waitcnt lgkmcnt(2)
    ds_read_b128 v[40:43], v19 offset:20480
    ds_read_b128 v[56:59], v18 offset:12288
    v_cvt_pk_bf16_f32 v127, v110, v111
    v_mfma_f32_16x16x32_bf16 v[148:151], v[44:47], a[100:103], v[148:151]
    v_pk_max_i16 v124, v124, 0
    v_pk_max_i16 v125, v125, 0
    v_pk_max_i16 v126, v126, 0
    v_pk_max_i16 v127, v127, 0
    v_mfma_f32_16x16x32_bf16 v[144:147], v[44:47], a[96:99], v[144:147]
    s_waitcnt lgkmcnt(3)
    ds_read_b128 v[44:47], v20 offset:20480
    buffer_store_dwordx4 v[124:127], v2, s[28:31], s46 offen offset:1024 sc1
    v_mfma_f32_16x16x32_bf16 v[152:155], v[48:51], a[96:99], v[152:155]
    buffer_load_dwordx4 v2, s[28:31], s42 offen offset:1024 sc1 lds
    v_mfma_f32_16x16x32_bf16 v[156:159], v[48:51], a[100:103], v[156:159]
    s_waitcnt lgkmcnt(3)
    ds_read_b128 v[48:51], v21 offset:20480
    v_lshrrev_b32 v172, 4, v1
    v_mfma_f32_16x16x32_bf16 v[164:167], v[52:55], a[100:103], v[164:167]
    v_and_b32 v173, 15, v1
    v_bfe_u32 v174, v1, 2, 2
    v_mfma_f32_16x16x32_bf16 v[160:163], v[52:55], a[96:99], v[160:163]
    s_waitcnt lgkmcnt(2)
    s_mul_i32 s56, s32, 0x880
    ds_read_b128 v[52:55], v22 offset:20480
    v_and_b32 v175, 3, v1
    v_mfma_f32_16x16x32_bf16 v[136:139], v[40:43], a[104:107], v[136:139]
    s_add_u32 s56, s56, 0x15000
    v_mul_u32_u24 v176, 0x88, v173
    v_add_u32 v176, s56, v176
    v_mfma_f32_16x16x32_bf16 v[140:143], v[40:43], a[108:111], v[140:143]
    v_add_u32 v14, 0x48, v176
    v_lshl_add_u32 v177, v172, 3, v176
    v_mfma_f32_16x16x32_bf16 v[168:171], v[40:43], v[56:59], v[168:171]
    s_waitcnt lgkmcnt(2)
    ds_read_b128 v[40:43], v19 offset:36864
    ds_read_b128 v[56:59], v17 offset:14336
    v_mfma_f32_16x16x32_bf16 v[148:151], v[44:47], a[108:111], v[148:151]
    buffer_load_dwordx4 v2, s[28:31], s42 offen offset:2048 sc1 lds
    v_mfma_f32_16x16x32_bf16 v[144:147], v[44:47], a[104:107], v[144:147]
    s_waitcnt lgkmcnt(3)
    ds_read_b128 v[44:47], v20 offset:36864
    v_add_u32 v13, 40, v177
    v_mfma_f32_16x16x32_bf16 v[152:155], v[48:51], a[104:107], v[152:155]
    v_add_u32 v4, 0x440, v177
    v_add_u32 v178, 0x460, v176
    v_mfma_f32_16x16x32_bf16 v[156:159], v[48:51], a[108:111], v[156:159]
    s_waitcnt lgkmcnt(3)
    ds_read_b128 v[48:51], v21 offset:36864
    v_mov_b32 v179, 0x27400
    v_mfma_f32_16x16x32_bf16 v[164:167], v[52:55], a[108:111], v[164:167]
    v_cmp_eq_u32 s[92:93], 0, v172
    s_nop 1
    v_cndmask_b32 v5, v179, v178, s[92:93]
    v_mfma_f32_16x16x32_bf16 v[160:163], v[52:55], a[104:107], v[160:163]
    s_waitcnt lgkmcnt(2)
    ds_read_b128 v[52:55], v22 offset:36864
    v_lshl_add_u32 v178, v172, 2, v174
    v_mfma_f32_16x16x32_bf16 v[136:139], v[40:43], a[112:115], v[136:139]
    v_mul_u32_u24 v178, 0x88, v178
    v_add_u32 v178, s56, v178
    v_mfma_f32_16x16x32_bf16 v[140:143], v[40:43], a[116:119], v[140:143]
    buffer_load_dwordx4 v2, s[28:31], s42 offen offset:3072 sc1 lds
    v_mfma_f32_16x16x32_bf16 v[168:171], v[40:43], v[56:59], v[168:171]
    s_waitcnt lgkmcnt(2)
    s_add_u32 s88, s88, 4
    ds_read_b128 v[40:43], v19 offset:53248
    ds_read_b128 v[56:59], v18 offset:14336
    v_mfma_f32_16x16x32_bf16 v[148:151], v[44:47], a[116:119], v[148:151]
    s_cmp_ge_u32 s88, 20
    s_cselect_b32 s42, 20, 0
    v_add_u32 v16, 0x70, v178
    v_mfma_f32_16x16x32_bf16 v[144:147], v[44:47], a[112:115], v[144:147]
    s_waitcnt lgkmcnt(3)
    s_sub_u32 s88, s88, s42
    ds_read_b128 v[44:47], v20 offset:53248
    v_lshl_add_u32 v178, v175, 3, v178
    v_mfma_f32_16x16x32_bf16 v[152:155], v[48:51], a[112:115], v[152:155]
    s_lshl_b32 s42, s88, 12
    v_add_u32 v15, 0x50, v178
    v_mul_u32_u24 v178, 40, v172
    v_mfma_f32_16x16x32_bf16 v[156:159], v[48:51], a[116:119], v[156:159]
    s_waitcnt lgkmcnt(3)
    s_add_u32 s42, s42, s89
    ds_read_b128 v[48:51], v21 offset:53248
    v_add_u32 v178, 32, v178
    v_mfma_f32_16x16x32_bf16 v[164:167], v[52:55], a[116:119], v[164:167]
    s_add_u32 s42, s42, 0x14000
    v_min_u32 v178, 0x78, v178
    v_lshlrev_b32 v179, 3, v172
    v_mfma_f32_16x16x32_bf16 v[160:163], v[52:55], a[112:115], v[160:163]
    s_waitcnt lgkmcnt(2)
    ds_read_b128 v[52:55], v22 offset:53248
    v_and_b32 v180, 1, v173
    v_mfma_f32_16x16x32_bf16 v[136:139], v[40:43], a[120:123], v[136:139]
    v_mul_u32_u24 v180, 0x2640, v180
    v_lshrrev_b32 v181, 1, v173
    v_mfma_f32_16x16x32_bf16 v[140:143], v[40:43], a[124:127], v[140:143]
    v_mul_u32_u24 v181, 0x88, v181
    v_add_u32 v180, v180, v181
    v_mfma_f32_16x16x32_bf16 v[168:171], v[40:43], v[56:59], v[168:171]
    s_waitcnt lgkmcnt(2)
    s_add_u32 s57, s32, 0
    s_and_b32 s57, s57, 3
    v_add_u32 v180, 0x15000, v180
    v_mfma_f32_16x16x32_bf16 v[148:151], v[44:47], a[124:127], v[148:151]
    s_mul_i32 s58, s57, 40
    s_cmp_eq_u32 s57, 3
    s_cselect_b64 s[92:93], -1, 0
    v_mfma_f32_16x16x32_bf16 v[144:147], v[44:47], a[120:123], v[144:147]
    s_waitcnt vmcnt(14) lgkmcnt(0)
    s_barrier
    buffer_load_dwordx4 v[248:251], v24, s[28:31], 0 offen sc1
    v_mfma_f32_16x16x32_bf16 v[152:155], v[48:51], a[120:123], v[152:155]
    s_add_u32 m0, s39, 0x1000
    ds_read_b128 v[40:43], v19 offset:8192
    ds_read_b128 v[56:59], v17 offset:16384
    v_mfma_f32_16x16x32_bf16 v[156:159], v[48:51], a[124:127], v[156:159]
    s_nop 0
    ds_read_b128 v[44:47], v20 offset:8192
    ds_read_b128 v[48:51], v21 offset:8192
    v_mfma_f32_16x16x32_bf16 v[164:167], v[52:55], a[124:127], v[164:167]
    buffer_load_dwordx4 v2, s[28:31], s42 offen sc1 lds
    v_mfma_f32_16x16x32_bf16 v[160:163], v[52:55], a[120:123], v[160:163]
    s_waitcnt lgkmcnt(3)
    ds_read_b128 v[52:55], v22 offset:8192
    v_add_u32 v181, s58, v179
    v_mfma_f32_16x16x32_bf16 v[136:139], v[40:43], a[128:131], v[136:139]
    v_cndmask_b32 v181, v181, v178, s[92:93]
    v_add_u32 v12, v180, v181
    v_mfma_f32_16x16x32_bf16 v[140:143], v[40:43], a[132:135], v[140:143]
    s_waitcnt lgkmcnt(3)
    s_add_u32 s57, s32, 1
    v_add_u32 v181, v176, v181
    v_add_u32 v8, 0x440, v181
    v_mfma_f32_16x16x32_bf16 v[168:171], v[40:43], v[56:59], v[168:171]
    s_waitcnt lgkmcnt(2)
    s_and_b32 s57, s57, 3
    ds_read_b128 v[40:43], v19 offset:24576
    ds_read_b128 v[56:59], v18 offset:16384
    v_mfma_f32_16x16x32_bf16 v[148:151], v[44:47], a[132:135], v[148:151]
    s_mul_i32 s58, s57, 40
    s_cmp_eq_u32 s57, 3
    s_cselect_b64 s[92:93], -1, 0
    v_mfma_f32_16x16x32_bf16 v[144:147], v[44:47], a[128:131], v[144:147]
    s_waitcnt lgkmcnt(3)
    ds_read_b128 v[44:47], v20 offset:24576
    v_add_u32 v181, s58, v179
    v_mfma_f32_16x16x32_bf16 v[152:155], v[48:51], a[128:131], v[152:155]
    buffer_load_dwordx4 v2, s[28:31], s42 offen offset:1024 sc1 lds
    v_mfma_f32_16x16x32_bf16 v[156:159], v[48:51], a[132:135], v[156:159]
    s_waitcnt lgkmcnt(3)
    ds_read_b128 v[48:51], v21 offset:24576
    v_cndmask_b32 v181, v181, v178, s[92:93]
    v_mfma_f32_16x16x32_bf16 v[164:167], v[52:55], a[132:135], v[164:167]
    s_add_u32 s57, s32, 2
    v_add_u32 v181, v176, v181
    v_add_u32 v9, 0x440, v181
    v_mfma_f32_16x16x32_bf16 v[160:163], v[52:55], a[128:131], v[160:163]
    s_waitcnt lgkmcnt(2)
    s_and_b32 s57, s57, 3
    ds_read_b128 v[52:55], v22 offset:24576
    s_mul_i32 s58, s57, 40
    v_mfma_f32_16x16x32_bf16 v[136:139], v[40:43], a[136:139], v[136:139]
    s_cmp_eq_u32 s57, 3
    s_cselect_b64 s[92:93], -1, 0
    v_add_u32 v181, s58, v179
    v_mfma_f32_16x16x32_bf16 v[140:143], v[40:43], a[140:143], v[140:143]
    v_cndmask_b32 v181, v181, v178, s[92:93]
    v_add_u32 v181, v176, v181
    v_mfma_f32_16x16x32_bf16 v[168:171], v[40:43], v[56:59], v[168:171]
    s_waitcnt lgkmcnt(2)
    ds_read_b128 v[40:43], v19 offset:40960
    ds_read_b128 v[56:59], v17 offset:18432
    v_mfma_f32_16x16x32_bf16 v[148:151], v[44:47], a[140:143], v[148:151]
    buffer_load_dwordx4 v2, s[28:31], s42 offen offset:2048 sc1 lds
    v_mfma_f32_16x16x32_bf16 v[144:147], v[44:47], a[136:139], v[144:147]
    s_waitcnt lgkmcnt(3)
    s_add_u32 s57, s32, 3
    ds_read_b128 v[44:47], v20 offset:40960
    v_add_u32 v10, 0x440, v181
    v_mfma_f32_16x16x32_bf16 v[152:155], v[48:51], a[136:139], v[152:155]
    s_and_b32 s57, s57, 3
    s_mul_i32 s58, s57, 40
    v_mfma_f32_16x16x32_bf16 v[156:159], v[48:51], a[140:143], v[156:159]
    s_waitcnt lgkmcnt(3)
    s_cmp_eq_u32 s57, 3
    s_cselect_b64 s[92:93], -1, 0
    ds_read_b128 v[48:51], v21 offset:40960
    v_mfma_f32_16x16x32_bf16 v[164:167], v[52:55], a[140:143], v[164:167]
    v_add_u32 v181, s58, v179
    v_cndmask_b32 v181, v181, v178, s[92:93]
    v_mfma_f32_16x16x32_bf16 v[160:163], v[52:55], a[136:139], v[160:163]
    s_waitcnt lgkmcnt(2)
    ds_read_b128 v[52:55], v22 offset:40960
    v_add_u32 v181, v176, v181
    v_mfma_f32_16x16x32_bf16 v[136:139], v[40:43], a[144:147], v[136:139]
    s_lshl_b32 s57, s32, 6
    s_add_u32 s57, s57, 0x27200
    v_add_u32 v11, 0x440, v181
    v_mfma_f32_16x16x32_bf16 v[140:143], v[40:43], a[148:151], v[140:143]
    buffer_load_dwordx4 v2, s[28:31], s42 offen offset:3072 sc1 lds
    v_mfma_f32_16x16x32_bf16 v[168:171], v[40:43], v[56:59], v[168:171]
    s_waitcnt lgkmcnt(2)
    s_add_u32 s88, s88, 4
    ds_read_b128 v[40:43], v19 offset:57344
    ds_read_b128 v[56:59], v18 offset:18432
    v_mfma_f32_16x16x32_bf16 v[148:151], v[44:47], a[148:151], v[148:151]
    s_cmp_ge_u32 s88, 20
    s_cselect_b32 s42, 20, 0
    v_lshl_add_u32 v7, v172, 4, s57
    v_mfma_f32_16x16x32_bf16 v[144:147], v[44:47], a[144:147], v[144:147]
    s_waitcnt lgkmcnt(3)
    s_sub_u32 s88, s88, s42
    ds_read_b128 v[44:47], v20 offset:57344
    v_lshlrev_b32 v6, 4, v172
    v_mfma_f32_16x16x32_bf16 v[152:155], v[48:51], a[144:147], v[152:155]
    s_lshl_b32 s42, s88, 12
    v_lshlrev_b32 v176, 4, v173
    v_lshl_add_u32 v176, v172, 10, v176
    v_mfma_f32_16x16x32_bf16 v[156:159], v[48:51], a[148:151], v[156:159]
    s_waitcnt lgkmcnt(3)
    s_add_u32 s42, s42, s89
    ds_read_b128 v[48:51], v21 offset:57344
    v_mov_b32 v177, 0x7ffffff0
    v_mfma_f32_16x16x32_bf16 v[164:167], v[52:55], a[148:151], v[164:167]
    s_add_u32 s42, s42, 0x14000
    v_cmp_gt_u32 s[92:93], 32, v1
    v_mfma_f32_16x16x32_bf16 v[160:163], v[52:55], a[144:147], v[160:163]
    s_waitcnt lgkmcnt(2)
    s_lshl_b32 s56, s33, 1
    ds_read_b128 v[52:55], v22 offset:57344
    v_cndmask_b32 v63, v177, v176, s[92:93]
    v_mfma_f32_16x16x32_bf16 v[136:139], v[40:43], a[152:155], v[136:139]
    s_lshr_b32 s57, s32, 1
    s_add_u32 s56, s56, s57
    s_lshl_b32 s56, s56, 7
    v_mfma_f32_16x16x32_bf16 v[140:143], v[40:43], a[156:159], v[140:143]
    s_and_b32 s57, s32, 1
    s_lshl1_add_u32 s57, s34, s57
    s_lshl2_add_u32 s56, s57, s56
    v_mfma_f32_16x16x32_bf16 v[168:171], v[40:43], v[56:59], v[168:171]
    s_waitcnt lgkmcnt(2)
    s_add_u32 s56, s56, 0x1800
    v_mov_b32 v194, s56
    v_mov_b32 v195, 0x7ffffff0
    v_mfma_f32_16x16x32_bf16 v[148:151], v[44:47], a[156:159], v[148:151]
    v_cmp_eq_u32 s[92:93], 0, v1
    s_nop 1
    v_cndmask_b32 v25, v195, v194, s[92:93]
    v_mfma_f32_16x16x32_bf16 v[144:147], v[44:47], a[152:155], v[144:147]
    s_waitcnt vmcnt(11) lgkmcnt(0)
    s_barrier
    ds_read_b128 v[40:43], v19 offset:12288
    ds_read_b128 v[56:59], v17
    v_mfma_f32_16x16x32_bf16 v[152:155], v[48:51], a[152:155], v[152:155]
    s_add_u32 m0, s39, 0x2000
    ds_read_b128 v[44:47], v20 offset:12288
    v_mfma_f32_16x16x32_bf16 v[156:159], v[48:51], a[156:159], v[156:159]
    ds_read_b128 v[48:51], v21 offset:12288
    v_mfma_f32_16x16x32_bf16 v[164:167], v[52:55], a[156:159], v[164:167]
    buffer_load_dwordx4 v2, s[28:31], s42 offen sc1 lds
    v_mfma_f32_16x16x32_bf16 v[160:163], v[52:55], a[152:155], v[160:163]
    s_waitcnt lgkmcnt(3)
    ds_read_b128 v[52:55], v22 offset:12288
    v_mfma_f32_16x16x32_bf16 v[64:67], v[40:43], a[0:3], 0
    v_mfma_f32_16x16x32_bf16 v[68:71], v[40:43], a[4:7], 0
    s_waitcnt lgkmcnt(3)
    v_mfma_f32_16x16x32_bf16 v[96:99], v[40:43], v[56:59], 0
    s_waitcnt lgkmcnt(2)
    ds_read_b128 v[40:43], v19 offset:28672
    ds_read_b128 v[56:59], v18
    v_mfma_f32_16x16x32_bf16 v[76:79], v[44:47], a[4:7], 0
    v_mfma_f32_16x16x32_bf16 v[72:75], v[44:47], a[0:3], 0
    s_waitcnt lgkmcnt(3)
    ds_read_b128 v[44:47], v20 offset:28672
    v_mfma_f32_16x16x32_bf16 v[80:83], v[48:51], a[0:3], 0
    buffer_load_dwordx4 v2, s[28:31], s42 offen offset:1024 sc1 lds
    v_mfma_f32_16x16x32_bf16 v[84:87], v[48:51], a[4:7], 0
    s_waitcnt lgkmcnt(3)
    ds_read_b128 v[48:51], v21 offset:28672
    v_mfma_f32_16x16x32_bf16 v[92:95], v[52:55], a[4:7], 0
    s_mov_b64 exec, s[70:71]
    ds_write_b128 v7, v[168:171]
    s_mov_b64 exec, -1
    v_mfma_f32_16x16x32_bf16 v[88:91], v[52:55], a[0:3], 0
    s_waitcnt lgkmcnt(3)
    ds_read_b128 v[52:55], v22 offset:28672
    v_mul_f32 v190, v28, v30
    v_mfma_f32_16x16x32_bf16 v[64:67], v[40:43], a[8:11], v[64:67]
    s_waitcnt vmcnt(10)
    buffer_store_dword v27, v25, s[28:31], 0 offen sc1
    v_mfma_f32_16x16x32_bf16 v[68:71], v[40:43], a[12:15], v[68:71]
    v_mul_f32 v191, v29, v31
    v_mul_f32 v136, v136, v30
    v_mfma_f32_16x16x32_bf16 v[96:99], v[40:43], v[56:59], v[96:99]
    s_waitcnt lgkmcnt(3)
    ds_read_b128 v[40:43], v19 offset:45056
    ds_read_b128 v[56:59], v17 offset:2048
    v_mfma_f32_16x16x32_bf16 v[76:79], v[44:47], a[12:15], v[76:79]
    buffer_load_dwordx4 v2, s[28:31], s42 offen offset:2048 sc1 lds
    v_mfma_f32_16x16x32_bf16 v[72:75], v[44:47], a[8:11], v[72:75]
    s_waitcnt lgkmcnt(3)
    ds_read_b128 v[44:47], v20 offset:45056
    v_mul_f32 v137, v137, v30
    v_mfma_f32_16x16x32_bf16 v[80:83], v[48:51], a[8:11], v[80:83]
    v_mul_f32 v138, v138, v30
    v_mul_f32 v139, v139, v30
    v_mfma_f32_16x16x32_bf16 v[84:87], v[48:51], a[12:15], v[84:87]
    s_waitcnt lgkmcnt(3)
    ds_read_b128 v[48:51], v21 offset:45056
    v_mul_f32 v140, v140, v31
    v_mfma_f32_16x16x32_bf16 v[92:95], v[52:55], a[12:15], v[92:95]
    v_mul_f32 v141, v141, v31
    v_mul_f32 v142, v142, v31
    v_mfma_f32_16x16x32_bf16 v[88:91], v[52:55], a[8:11], v[88:91]
    s_waitcnt lgkmcnt(2)
    ds_read_b128 v[52:55], v22 offset:45056
    v_mul_f32 v143, v143, v31
    v_mfma_f32_16x16x32_bf16 v[64:67], v[40:43], a[16:19], v[64:67]
    v_mul_f32 v144, v144, v30
    v_mul_f32 v145, v145, v30
    v_mfma_f32_16x16x32_bf16 v[68:71], v[40:43], a[20:23], v[68:71]
    buffer_load_dwordx4 v2, s[28:31], s42 offen offset:3072 sc1 lds
    s_barrier
    v_mul_f32 v146, v146, v30
    v_mfma_f32_16x16x32_bf16 v[96:99], v[40:43], v[56:59], v[96:99]
    s_waitcnt lgkmcnt(2)
    s_add_u32 s88, s88, 4
    ds_read_b128 v[40:43], v19 offset:61440
    ds_read_b128 v[56:59], v18 offset:2048
    v_mul_f32 v147, v147, v30
    v_mfma_f32_16x16x32_bf16 v[76:79], v[44:47], a[20:23], v[76:79]
    s_cmp_ge_u32 s88, 20
    s_cselect_b32 s42, 20, 0
    v_mul_f32 v148, v148, v31
    v_mul_f32 v149, v149, v31
    v_mfma_f32_16x16x32_bf16 v[72:75], v[44:47], a[16:19], v[72:75]
    s_waitcnt lgkmcnt(3)
    s_sub_u32 s88, s88, s42
    ds_read_b128 v[44:47], v20 offset:61440
    v_mul_f32 v150, v150, v31
    v_mul_f32 v151, v151, v31
    v_mfma_f32_16x16x32_bf16 v[80:83], v[48:51], a[16:19], v[80:83]
    s_lshl_b32 s42, s88, 12
    v_mul_f32 v152, v152, v30
    v_mul_f32 v153, v153, v30
    v_mul_f32 v154, v154, v30
    v_mfma_f32_16x16x32_bf16 v[84:87], v[48:51], a[20:23], v[84:87]
    s_waitcnt lgkmcnt(3)
    s_add_u32 s42, s42, s89
    ds_read_b128 v[48:51], v21 offset:61440
    v_mul_f32 v155, v155, v30
    v_mul_f32 v156, v156, v31
    v_mfma_f32_16x16x32_bf16 v[92:95], v[52:55], a[20:23], v[92:95]
    s_add_u32 s42, s42, 0x14000
    v_mul_f32 v157, v157, v31
    v_mul_f32 v158, v158, v31
    v_mul_f32 v159, v159, v31
    v_mfma_f32_16x16x32_bf16 v[88:91], v[52:55], a[16:19], v[88:91]
    s_waitcnt lgkmcnt(2)
    ds_read_b128 v[52:55], v22 offset:61440
    v_mul_f32 v160, v160, v30
    v_mul_f32 v161, v161, v30
    v_mfma_f32_16x16x32_bf16 v[64:67], v[40:43], a[24:27], v[64:67]
    v_mul_f32 v162, v162, v30
    v_mul_f32 v163, v163, v30
    v_mul_f32 v164, v164, v31
    v_mfma_f32_16x16x32_bf16 v[68:71], v[40:43], a[28:31], v[68:71]
    s_add_u32 s56, s32, 0
    v_mul_f32 v165, v165, v31
    v_mul_f32 v166, v166, v31
    v_mul_f32 v167, v167, v31
    v_mfma_f32_16x16x32_bf16 v[96:99], v[40:43], v[56:59], v[96:99]
    s_waitcnt lgkmcnt(2)
    s_and_b32 s56, s56, 3
    s_lshl_b32 s56, s56, 6
    s_add_u32 s56, s56, 0x27200
    v_add_u32 v192, s56, v6
    v_mfma_f32_16x16x32_bf16 v[76:79], v[44:47], a[28:31], v[76:79]
    s_add_u32 s56, s32, 1
    ds_read_b128 v[172:175], v192
    s_and_b32 s56, s56, 3
    s_lshl_b32 s56, s56, 6
    v_mfma_f32_16x16x32_bf16 v[72:75], v[44:47], a[24:27], v[72:75]
    s_waitcnt vmcnt(9)
    v_xor_b32 v248, s81, v248
    v_xor_b32 v249, s81, v249
    v_xor_b32 v250, s81, v250
    v_xor_b32 v251, s81, v251
    v_or3_b32 v248, v248, v249, v250
    v_or_b32 v248, v248, v251
    v_cmp_ne_u32 vcc, 0, v248
    s_nop 0
    s_cbranch_vccnz L_slow_f2
L_ok_f2:
    s_waitcnt lgkmcnt(0)
    s_barrier
    v_mfma_f32_16x16x32_bf16 v[80:83], v[48:51], a[24:27], v[80:83]
    s_add_u32 m0, s39, 0x3000
    ds_read_b128 v[40:43], v19
    ds_read_b128 v[56:59], v17 offset:4096
    s_add_u32 s56, s56, 0x27200
    v_mfma_f32_16x16x32_bf16 v[84:87], v[48:51], a[28:31], v[84:87]
    s_lshl_b32 s96, s35, 7
    ds_read_b128 v[44:47], v20
    ds_read_b128 v[48:51], v21
    v_add_u32 v192, s56, v6
    v_mfma_f32_16x16x32_bf16 v[92:95], v[52:55], a[28:31], v[92:95]
    s_add_u32 s96, s96, 0x1800
    buffer_load_dwordx4 v2, s[28:31], s42 offen sc1 lds
    ds_read_b128 v[176:179], v192
    v_mfma_f32_16x16x32_bf16 v[88:91], v[52:55], a[24:27], v[88:91]
    s_waitcnt lgkmcnt(4)
    ds_read_b128 v[52:55], v22
    s_add_u32 s80, s52, 0
    buffer_load_dwordx4 a[160:163], v2, s[28:31], s80 offen sc1
    v_mfma_f32_16x16x32_bf16 v[64:67], v[40:43], a[32:35], v[64:67]
    s_add_u32 s56, s32, 2
    buffer_load_dwordx4 a[164:167], v2, s[28:31], s80 offen offset:1024 sc1
    s_and_b32 s56, s56, 3
    v_mfma_f32_16x16x32_bf16 v[68:71], v[40:43], a[36:39], v[68:71]
    s_waitcnt lgkmcnt(4)
    s_cmp_eq_u32 s32, 0
    s_cselect_b32 s96, s96, 0x7ffffff0
    s_lshl_b32 s56, s56, 6
    v_and_b32 v60, 31, v1
    v_mfma_f32_16x16x32_bf16 v[96:99], v[40:43], v[56:59], v[96:99]
    s_waitcnt lgkmcnt(3)
    s_add_u32 s56, s56, 0x27200
    ds_read_b128 v[40:43], v19 offset:16384
    ds_read_b128 v[56:59], v18 offset:4096
    v_add_u32 v192, s56, v6
    v_mfma_f32_16x16x32_bf16 v[76:79], v[44:47], a[36:39], v[76:79]
    s_add_u32 s56, s32, 3
    buffer_load_dwordx4 a[168:171], v2, s[28:31], s80 offen offset:2048 sc1
    ds_read_b128 v[180:183], v192
    v_mfma_f32_16x16x32_bf16 v[72:75], v[44:47], a[32:35], v[72:75]
    s_waitcnt lgkmcnt(4)
    s_and_b32 s56, s56, 3
    ds_read_b128 v[44:47], v20 offset:16384
    s_lshl_b32 s56, s56, 6
    v_lshl_add_u32 v24, v60, 2, s96
    v_mfma_f32_16x16x32_bf16 v[80:83], v[48:51], a[32:35], v[80:83]
    s_add_u32 s56, s56, 0x27200
    buffer_load_dwordx4 v2, s[28:31], s42 offen offset:1024 sc1 lds
    v_add_u32 v192, s56, v6
    v_mfma_f32_16x16x32_bf16 v[84:87], v[48:51], a[36:39], v[84:87]
    s_waitcnt lgkmcnt(4)
    ds_read_b128 v[48:51], v21 offset:16384
    ds_read_b128 v[184:187], v192
    v_mfma_f32_16x16x32_bf16 v[92:95], v[52:55], a[36:39], v[92:95]
    buffer_load_dwordx4 a[172:175], v2, s[28:31], s80 offen offset:3072 sc1
    v_mfma_f32_16x16x32_bf16 v[88:91], v[52:55], a[32:35], v[88:91]
    s_waitcnt lgkmcnt(4)
    ds_read_b128 v[52:55], v22 offset:16384
    v_fma_f32 v168, -v61, v172, v168
    v_fma_f32 v169, -v61, v173, v169
    v_mfma_f32_16x16x32_bf16 v[64:67], v[40:43], a[40:43], v[64:67]
    v_fma_f32 v170, -v61, v174, v170
    v_fma_f32 v171, -v61, v175, v171
    v_mul_f32 v168, v168, v62
    v_mfma_f32_16x16x32_bf16 v[68:71], v[40:43], a[44:47], v[68:71]
    buffer_load_dwordx4 a[176:179], v3, s[28:31], s80 offen sc1
    v_mul_f32 v169, v169, v62
    v_mfma_f32_16x16x32_bf16 v[96:99], v[40:43], v[56:59], v[96:99]
    s_waitcnt lgkmcnt(3)
    ds_read_b128 v[40:43], v19 offset:32768
    ds_read_b128 v[56:59], v17 offset:6144
    v_mul_f32 v170, v170, v62
    v_mfma_f32_16x16x32_bf16 v[76:79], v[44:47], a[44:47], v[76:79]
    v_mul_f32 v171, v171, v62
    v_cvt_pk_bf16_f32 v188, v168, v169
    v_cvt_pk_bf16_f32 v189, v170, v171
    v_mfma_f32_16x16x32_bf16 v[72:75], v[44:47], a[40:43], v[72:75]
    s_waitcnt lgkmcnt(3)
    ds_read_b128 v[44:47], v20 offset:32768
    ds_write_b64 v12, v[188:189]
    v_mfma_f32_16x16x32_bf16 v[80:83], v[48:51], a[40:43], v[80:83]
    buffer_load_dwordx4 v2, s[28:31], s42 offen offset:2048 sc1 lds
    v_fma_f32 v136, -v190, v172, v136
    v_mfma_f32_16x16x32_bf16 v[84:87], v[48:51], a[44:47], v[84:87]
    s_waitcnt lgkmcnt(4)
    ds_read_b128 v[48:51], v21 offset:32768
    v_fma_f32 v137, -v190, v173, v137
    v_fma_f32 v138, -v190, v174, v138
    v_mfma_f32_16x16x32_bf16 v[92:95], v[52:55], a[44:47], v[92:95]
    s_add_u32 s80, s52, 0x1400
    buffer_load_dwordx4 a[180:183], v2, s[28:31], s80 offen sc1
    v_fma_f32 v139, -v190, v175, v139
    v_mfma_f32_16x16x32_bf16 v[88:91], v[52:55], a[40:43], v[88:91]
    s_waitcnt lgkmcnt(3)
    ds_read_b128 v[52:55], v22 offset:32768
    v_cvt_pk_bf16_f32 v136, v136, v137
    v_cvt_pk_bf16_f32 v137, v138, v139
    v_mfma_f32_16x16x32_bf16 v[64:67], v[40:43], a[48:51], v[64:67]
    buffer_load_dwordx4 a[184:187], v2, s[28:31], s80 offen offset:1024 sc1
    v_mfma_f32_16x16x32_bf16 v[68:71], v[40:43], a[52:55], v[68:71]
    ds_write_b64 v8, v[136:137]
    v_fma_f32 v140, -v191, v172, v140
    v_mfma_f32_16x16x32_bf16 v[96:99], v[40:43], v[56:59], v[96:99]
    s_waitcnt lgkmcnt(3)
    ds_read_b128 v[40:43], v19 offset:49152
    ds_read_b128 v[56:59], v18 offset:6144
    v_fma_f32 v141, -v191, v173, v141
    v_mfma_f32_16x16x32_bf16 v[76:79], v[44:47], a[52:55], v[76:79]
    buffer_load_dwordx4 v2, s[28:31], s42 offen offset:3072 sc1 lds
    v_fma_f32 v142, -v191, v174, v142
    v_mfma_f32_16x16x32_bf16 v[72:75], v[44:47], a[48:51], v[72:75]
    s_waitcnt lgkmcnt(4)
    ds_read_b128 v[44:47], v20 offset:49152
    v_fma_f32 v143, -v191, v175, v143
    v_cvt_pk_bf16_f32 v140, v140, v141
    v_mfma_f32_16x16x32_bf16 v[80:83], v[48:51], a[48:51], v[80:83]
    buffer_load_dwordx4 a[188:191], v2, s[28:31], s80 offen offset:2048 sc1
    v_cvt_pk_bf16_f32 v141, v142, v143
    v_mfma_f32_16x16x32_bf16 v[84:87], v[48:51], a[52:55], v[84:87]
    s_waitcnt lgkmcnt(4)
    ds_read_b128 v[48:51], v21 offset:49152
    ds_write_b64 v8, v[140:141] offset:9792
    v_mfma_f32_16x16x32_bf16 v[92:95], v[52:55], a[52:55], v[92:95]
    buffer_load_dwordx4 a[192:195], v2, s[28:31], s80 offen offset:3072 sc1
    v_fma_f32 v144, -v190, v176, v144
    v_mfma_f32_16x16x32_bf16 v[88:91], v[52:55], a[48:51], v[88:91]
    s_waitcnt lgkmcnt(3)
    ds_read_b128 v[52:55], v22 offset:49152
    v_fma_f32 v145, -v190, v177, v145
    v_fma_f32 v146, -v190, v178, v146
    v_mfma_f32_16x16x32_bf16 v[64:67], v[40:43], a[56:59], v[64:67]
    buffer_load_dwordx4 a[196:199], v3, s[28:31], s80 offen sc1
    v_fma_f32 v147, -v190, v179, v147
    v_mfma_f32_16x16x32_bf16 v[68:71], v[40:43], a[60:63], v[68:71]
    v_cvt_pk_bf16_f32 v144, v144, v145
    v_cvt_pk_bf16_f32 v145, v146, v147
    v_mfma_f32_16x16x32_bf16 v[96:99], v[40:43], v[56:59], v[96:99]
    s_waitcnt lgkmcnt(3)
    ds_write_b64 v9, v[144:145]
    v_fma_f32 v148, -v191, v176, v148
    v_mfma_f32_16x16x32_bf16 v[76:79], v[44:47], a[60:63], v[76:79]
    v_fma_f32 v149, -v191, v177, v149
    v_fma_f32 v150, -v191, v178, v150
    v_fma_f32 v151, -v191, v179, v151
    v_mfma_f32_16x16x32_bf16 v[72:75], v[44:47], a[56:59], v[72:75]
    s_waitcnt vmcnt(19) lgkmcnt(0)
    s_barrier
    ds_read_b128 v[40:43], v19 offset:4096
    ds_read_b128 v[56:59], v17 offset:8192
    v_cvt_pk_bf16_f32 v148, v148, v149
    v_mfma_f32_16x16x32_bf16 v[80:83], v[48:51], a[56:59], v[80:83]
    ds_read_b128 v[44:47], v20 offset:4096
    s_add_u32 s80, s52, 0x2800
    buffer_load_dwordx4 a[200:203], v2, s[28:31], s80 offen sc1
    v_mfma_f32_16x16x32_bf16 v[84:87], v[48:51], a[60:63], v[84:87]
    ds_read_b128 v[48:51], v21 offset:4096
    v_cvt_pk_bf16_f32 v149, v150, v151
    v_mfma_f32_16x16x32_bf16 v[92:95], v[52:55], a[60:63], v[92:95]
    buffer_load_dwordx4 a[204:207], v2, s[28:31], s80 offen offset:1024 sc1
    v_mfma_f32_16x16x32_bf16 v[88:91], v[52:55], a[56:59], v[88:91]
    s_waitcnt lgkmcnt(3)
    ds_read_b128 v[52:55], v22 offset:4096
    ds_write_b64 v9, v[148:149] offset:9792
    v_mfma_f32_16x16x32_bf16 v[64:67], v[40:43], a[64:67], v[64:67]
    v_fma_f32 v152, -v190, v180, v152
    v_fma_f32 v153, -v190, v181, v153
    v_fma_f32 v154, -v190, v182, v154
    v_mfma_f32_16x16x32_bf16 v[68:71], v[40:43], a[68:71], v[68:71]
    s_waitcnt lgkmcnt(4)
    v_fma_f32 v155, -v190, v183, v155
    v_cvt_pk_bf16_f32 v152, v152, v153
    v_cvt_pk_bf16_f32 v153, v154, v155
    v_mfma_f32_16x16x32_bf16 v[96:99], v[40:43], v[56:59], v[96:99]
    s_waitcnt lgkmcnt(3)
    ds_read_b128 v[40:43], v19 offset:20480
    ds_read_b128 v[56:59], v18 offset:8192
    v_mfma_f32_16x16x32_bf16 v[76:79], v[44:47], a[68:71], v[76:79]
    buffer_load_dwordx4 a[208:211], v2, s[28:31], s80 offen offset:2048 sc1
    v_mfma_f32_16x16x32_bf16 v[72:75], v[44:47], a[64:67], v[72:75]
    s_waitcnt lgkmcnt(4)
    ds_read_b128 v[44:47], v20 offset:20480
    ds_write_b64 v10, v[152:153]
    v_mfma_f32_16x16x32_bf16 v[80:83], v[48:51], a[64:67], v[80:83]
    buffer_load_dwordx4 a[212:215], v2, s[28:31], s80 offen offset:3072 sc1
    v_fma_f32 v156, -v191, v180, v156
    v_mfma_f32_16x16x32_bf16 v[84:87], v[48:51], a[68:71], v[84:87]
    s_waitcnt lgkmcnt(4)
    ds_read_b128 v[48:51], v21 offset:20480
    v_fma_f32 v157, -v191, v181, v157
    v_fma_f32 v158, -v191, v182, v158
    v_mfma_f32_16x16x32_bf16 v[92:95], v[52:55], a[68:71], v[92:95]
    v_fma_f32 v159, -v191, v183, v159
    v_cvt_pk_bf16_f32 v156, v156, v157
    v_cvt_pk_bf16_f32 v157, v158, v159
    v_mfma_f32_16x16x32_bf16 v[88:91], v[52:55], a[64:67], v[88:91]
    s_waitcnt lgkmcnt(3)
    ds_read_b128 v[52:55], v22 offset:20480
    ds_write_b64 v10, v[156:157] offset:9792
    v_mfma_f32_16x16x32_bf16 v[64:67], v[40:43], a[72:75], v[64:67]
    buffer_load_dwordx4 a[216:219], v3, s[28:31], s80 offen sc1
    v_fma_f32 v160, -v190, v184, v160
    v_mfma_f32_16x16x32_bf16 v[68:71], v[40:43], a[76:79], v[68:71]
    v_fma_f32 v161, -v190, v185, v161
    v_fma_f32 v162, -v190, v186, v162
    v_fma_f32 v163, -v190, v187, v163
    v_mfma_f32_16x16x32_bf16 v[96:99], v[40:43], v[56:59], v[96:99]
    s_waitcnt lgkmcnt(3)
    ds_read_b128 v[40:43], v19 offset:36864
    ds_read_b128 v[56:59], v17 offset:10240
    v_cvt_pk_bf16_f32 v160, v160, v161
    v_mfma_f32_16x16x32_bf16 v[76:79], v[44:47], a[76:79], v[76:79]
    s_add_u32 s80, s52, 0x3c00
    buffer_load_dwordx4 a[220:223], v2, s[28:31], s80 offen sc1
    v_cvt_pk_bf16_f32 v161, v162, v163
    v_mfma_f32_16x16x32_bf16 v[72:75], v[44:47], a[72:75], v[72:75]
    s_waitcnt lgkmcnt(4)
    ds_read_b128 v[44:47], v20 offset:36864
    ds_write_b64 v11, v[160:161]
    v_mfma_f32_16x16x32_bf16 v[80:83], v[48:51], a[72:75], v[80:83]
    v_fma_f32 v164, -v191, v184, v164
    v_fma_f32 v165, -v191, v185, v165
    v_fma_f32 v166, -v191, v186, v166
    v_mfma_f32_16x16x32_bf16 v[84:87], v[48:51], a[76:79], v[84:87]
    s_waitcnt lgkmcnt(4)
    ds_read_b128 v[48:51], v21 offset:36864
    v_fma_f32 v167, -v191, v187, v167
    v_cvt_pk_bf16_f32 v164, v164, v165
    v_mfma_f32_16x16x32_bf16 v[92:95], v[52:55], a[76:79], v[92:95]
    buffer_load_dwordx4 a[224:227], v2, s[28:31], s80 offen offset:1024 sc1
    v_cvt_pk_bf16_f32 v165, v166, v167
    v_mfma_f32_16x16x32_bf16 v[88:91], v[52:55], a[72:75], v[88:91]
    s_waitcnt lgkmcnt(3)
    ds_read_b128 v[52:55], v22 offset:36864
    ds_write_b64 v11, v[164:165] offset:9792
    v_mfma_f32_16x16x32_bf16 v[64:67], v[40:43], a[80:83], v[64:67]
    v_mfma_f32_16x16x32_bf16 v[68:71], v[40:43], a[84:87], v[68:71]
    buffer_load_dwordx4 a[228:231], v2, s[28:31], s80 offen offset:2048 sc1
    v_mfma_f32_16x16x32_bf16 v[96:99], v[40:43], v[56:59], v[96:99]
    ds_read_b128 v[40:43], v19 offset:53248
    ds_read_b128 v[56:59], v18 offset:10240
    s_waitcnt lgkmcnt(2)
    s_barrier
    v_add_u32 v183, 0, v5
    v_mfma_f32_16x16x32_bf16 v[76:79], v[44:47], a[84:87], v[76:79]
    v_add_u32 v195, 0x2640, v5
    v_cndmask_b32 v182, v5, v183, s[0:1]
    v_cndmask_b32 v194, v5, v195, s[0:1]
    v_mfma_f32_16x16x32_bf16 v[72:75], v[44:47], a[80:83], v[72:75]
    ds_read_b128 v[44:47], v20 offset:53248
    ds_read_b64 v[144:145], v4
    ds_read_b64 v[160:161], v4 offset:9792
    v_mfma_f32_16x16x32_bf16 v[80:83], v[48:51], a[80:83], v[80:83]
    buffer_load_dwordx4 a[232:235], v2, s[28:31], s80 offen offset:3072 sc1
    ds_read_b64 v[146:147], v182
    v_mfma_f32_16x16x32_bf16 v[84:87], v[48:51], a[84:87], v[84:87]
    ds_read_b128 v[48:51], v21 offset:53248
    ds_read_b64 v[162:163], v194
    ds_read_b64 v[136:137], v13
    v_mfma_f32_16x16x32_bf16 v[92:95], v[52:55], a[84:87], v[92:95]
    ds_read_b64 v[152:153], v13 offset:9792
    ds_read_b64 v[138:139], v14
    ds_read_b64 v[154:155], v14 offset:9792
    v_mfma_f32_16x16x32_bf16 v[88:91], v[52:55], a[80:83], v[88:91]
    s_waitcnt lgkmcnt(10)
    ds_read_b128 v[52:55], v22 offset:53248
    ds_read_b64 v[140:141], v13 offset:1088
    ds_read_b64 v[156:157], v13 offset:10880
    v_mfma_f32_16x16x32_bf16 v[64:67], v[40:43], a[88:91], v[64:67]
    buffer_load_dwordx4 a[236:239], v3, s[28:31], s80 offen sc1
    ds_read_b64 v[142:143], v14 offset:1088
    ds_read_b64 v[158:159], v14 offset:10880
    v_mfma_f32_16x16x32_bf16 v[68:71], v[40:43], a[92:95], v[68:71]
    v_mfma_f32_16x16x32_bf16 v[96:99], v[40:43], v[56:59], v[96:99]
    s_waitcnt lgkmcnt(6)
    s_add_u32 s80, s52, 0x5000
    buffer_load_dwordx4 v[196:199], v2, s[28:31], s80 offen sc1
    v_mfma_f32_16x16x32_bf16 v[172:175], v[136:139], v[144:147], v[32:35]
    v_mfma_f32_16x16x32_bf16 v[76:79], v[44:47], a[92:95], v[76:79]
    s_waitcnt lgkmcnt(5)
    v_mfma_f32_16x16x32_bf16 v[184:187], v[152:155], v[160:163], v[32:35]
    v_mfma_f32_16x16x32_bf16 v[72:75], v[44:47], a[88:91], v[72:75]
    s_waitcnt vmcnt(25) lgkmcnt(0)
    s_barrier
    buffer_load_dword v23, v24, s[28:31], 0 offen sc1
    v_mfma_f32_16x16x32_bf16 v[176:179], v[140:143], v[144:147], v[36:39]
    v_mfma_f32_16x16x32_bf16 v[80:83], v[48:51], a[88:91], v[80:83]
    s_nop 0
    ds_read_b128 v[40:43], v19 offset:8192
    ds_read_b128 v[56:59], v17 offset:12288
    v_mfma_f32_16x16x32_bf16 v[188:191], v[156:159], v[160:163], v[36:39]
    v_mfma_f32_16x16x32_bf16 v[84:87], v[48:51], a[92:95], v[84:87]
    ds_read_b128 v[44:47], v20 offset:8192
    ds_read_b128 v[48:51], v21 offset:8192
    ds_read_b64_tr_b16 v[136:137], v15
    v_mfma_f32_16x16x32_bf16 v[92:95], v[52:55], a[92:95], v[92:95]
    buffer_load_dwordx4 v[200:203], v2, s[28:31], s80 offen offset:1024 sc1
    ds_read_b64_tr_b16 v[152:153], v15 offset:9792
    v_mfma_f32_16x16x32_bf16 v[88:91], v[52:55], a[88:91], v[88:91]
    s_waitcnt lgkmcnt(5)
    ds_read_b128 v[52:55], v22 offset:8192
    ds_read_b64_tr_b16 v[140:141], v16
    ds_read_b64_tr_b16 v[156:157], v16 offset:9792
    ds_read_b64_tr_b16 v[138:139], v15 offset:1088
    v_mfma_f32_16x16x32_bf16 v[64:67], v[40:43], a[96:99], v[64:67]
    buffer_load_dwordx4 v[204:207], v2, s[28:31], s80 offen offset:2048 sc1
    ds_read_b64_tr_b16 v[154:155], v15 offset:10880
    v_mfma_f32_16x16x32_bf16 v[68:71], v[40:43], a[100:103], v[68:71]
    s_waitcnt lgkmcnt(9)
    ds_read_b64_tr_b16 v[142:143], v16 offset:1088
    ds_read_b64_tr_b16 v[158:159], v16 offset:10880
    v_mfma_f32_16x16x32_bf16 v[96:99], v[40:43], v[56:59], v[96:99]
    s_waitcnt lgkmcnt(10)
    ds_read_b128 v[40:43], v19 offset:24576
    ds_read_b128 v[56:59], v18 offset:12288
    v_max3_f32 v180, v172, v173, v174
    v_mfma_f32_16x16x32_bf16 v[76:79], v[44:47], a[100:103], v[76:79]
    buffer_load_dwordx4 v[208:211], v2, s[28:31], s80 offen offset:3072 sc1
    v_max3_f32 v192, v184, v185, v186
    v_mfma_f32_16x16x32_bf16 v[72:75], v[44:47], a[96:99], v[72:75]
    s_waitcnt lgkmcnt(9)
    ds_read_b128 v[44:47], v20 offset:24576
    v_max3_f32 v181, v175, v176, v177
    v_max3_f32 v193, v187, v188, v189
    v_mfma_f32_16x16x32_bf16 v[80:83], v[48:51], a[96:99], v[80:83]
    v_max3_f32 v180, v180, v178, v179
    v_max3_f32 v192, v192, v190, v191
    v_max_f32 v180, v180, v181
    v_mfma_f32_16x16x32_bf16 v[84:87], v[48:51], a[100:103], v[84:87]
    s_waitcnt lgkmcnt(5)
    ds_read_b128 v[48:51], v21 offset:24576
    v_max_f32 v192, v192, v193
    v_mov_b32 v181, v180
    v_mfma_f32_16x16x32_bf16 v[92:95], v[52:55], a[100:103], v[92:95]
    buffer_load_dwordx4 v[212:215], v3, s[28:31], s80 offen sc1
    v_mov_b32 v193, v192
    v_permlane16_swap_b32 v180, v181
    v_mfma_f32_16x16x32_bf16 v[88:91], v[52:55], a[96:99], v[88:91]
    s_waitcnt lgkmcnt(2)
    ds_read_b128 v[52:55], v22 offset:24576
    v_permlane16_swap_b32 v192, v193
    v_max_f32 v180, v180, v181
    v_mfma_f32_16x16x32_bf16 v[64:67], v[40:43], a[104:107], v[64:67]
    v_max_f32 v192, v192, v193
    v_mov_b32 v181, v180
    v_mov_b32 v193, v192
    v_mfma_f32_16x16x32_bf16 v[68:71], v[40:43], a[108:111], v[68:71]
    s_add_u32 s80, s52, 0x6400
    buffer_load_dwordx4 v[216:219], v2, s[28:31], s80 offen sc1
    v_permlane32_swap_b32 v180, v181
    v_mfma_f32_16x16x32_bf16 v[96:99], v[40:43], v[56:59], v[96:99]
    s_waitcnt lgkmcnt(2)
    ds_read_b128 v[40:43], v19 offset:40960
    ds_read_b128 v[56:59], v17 offset:14336
    v_permlane32_swap_b32 v192, v193
    v_mfma_f32_16x16x32_bf16 v[76:79], v[44:47], a[108:111], v[76:79]
    v_max_f32 v180, v180, v181
    v_max_f32 v192, v192, v193
    v_mul_f32 v180, s78, v180
    v_mfma_f32_16x16x32_bf16 v[72:75], v[44:47], a[104:107], v[72:75]
    s_waitcnt lgkmcnt(3)
    ds_read_b128 v[44:47], v20 offset:40960
    v_mul_f32 v192, s78, v192
    v_fma_f32 v172, v172, s78, -v180
    v_mfma_f32_16x16x32_bf16 v[80:83], v[48:51], a[104:107], v[80:83]
    buffer_load_dwordx4 v[220:223], v2, s[28:31], s80 offen offset:1024 sc1
    v_fma_f32 v184, v184, s78, -v192
    v_mfma_f32_16x16x32_bf16 v[84:87], v[48:51], a[108:111], v[84:87]
    s_waitcnt lgkmcnt(3)
    ds_read_b128 v[48:51], v21 offset:40960
    v_fma_f32 v173, v173, s78, -v180
    v_fma_f32 v185, v185, s78, -v192
    v_fma_f32 v174, v174, s78, -v180
    v_mfma_f32_16x16x32_bf16 v[92:95], v[52:55], a[108:111], v[92:95]
    v_fma_f32 v186, v186, s78, -v192
    v_fma_f32 v175, v175, s78, -v180
    v_fma_f32 v187, v187, s78, -v192
    v_mfma_f32_16x16x32_bf16 v[88:91], v[52:55], a[104:107], v[88:91]
    s_waitcnt lgkmcnt(2)
    ds_read_b128 v[52:55], v22 offset:40960
    v_fma_f32 v176, v176, s78, -v180
    v_fma_f32 v188, v188, s78, -v192
    v_mfma_f32_16x16x32_bf16 v[64:67], v[40:43], a[112:115], v[64:67]
    buffer_load_dwordx4 v[224:227], v2, s[28:31], s80 offen offset:2048 sc1
    v_fma_f32 v177, v177, s78, -v180
    v_mfma_f32_16x16x32_bf16 v[68:71], v[40:43], a[116:119], v[68:71]
    v_fma_f32 v189, v189, s78, -v192
    v_fma_f32 v178, v178, s78, -v180
    v_fma_f32 v190, v190, s78, -v192
    v_mfma_f32_16x16x32_bf16 v[96:99], v[40:43], v[56:59], v[96:99]
    s_waitcnt lgkmcnt(2)
    ds_read_b128 v[40:43], v19 offset:57344
    ds_read_b128 v[56:59], v18 offset:14336
    v_fma_f32 v179, v179, s78, -v180
    v_mfma_f32_16x16x32_bf16 v[76:79], v[44:47], a[116:119], v[76:79]
    buffer_load_dwordx4 v[228:231], v2, s[28:31], s80 offen offset:3072 sc1
    v_fma_f32 v191, v191, s78, -v192
    v_mfma_f32_16x16x32_bf16 v[72:75], v[44:47], a[112:115], v[72:75]
    s_waitcnt lgkmcnt(3)
    ds_read_b128 v[44:47], v20 offset:57344
    v_exp_f32 v172, v172
    v_mfma_f32_16x16x32_bf16 v[80:83], v[48:51], a[112:115], v[80:83]
    v_exp_f32 v184, v184
    v_exp_f32 v173, v173
    v_mfma_f32_16x16x32_bf16 v[84:87], v[48:51], a[116:119], v[84:87]
    s_waitcnt lgkmcnt(3)
    ds_read_b128 v[48:51], v21 offset:57344
    v_exp_f32 v185, v185
    v_mfma_f32_16x16x32_bf16 v[92:95], v[52:55], a[116:119], v[92:95]
    buffer_load_dwordx4 v[232:235], v3, s[28:31], s80 offen sc1
    v_mfma_f32_16x16x32_bf16 v[88:91], v[52:55], a[112:115], v[88:91]
    s_waitcnt lgkmcnt(2)
    ds_read_b128 v[52:55], v22 offset:57344
    v_exp_f32 v174, v174
    v_mfma_f32_16x16x32_bf16 v[64:67], v[40:43], a[120:123], v[64:67]
    s_add_u32 s80, s52, 0x7800
    buffer_load_dwordx4 v[236:239], v2, s[28:31], s80 offen sc1
    v_mfma_f32_16x16x32_bf16 v[68:71], v[40:43], a[124:127], v[68:71]
    v_exp_f32 v186, v186
    v_mfma_f32_16x16x32_bf16 v[96:99], v[40:43], v[56:59], v[96:99]
    s_waitcnt lgkmcnt(2)
    v_exp_f32 v175, v175
    v_mfma_f32_16x16x32_bf16 v[76:79], v[44:47], a[124:127], v[76:79]
    v_exp_f32 v187, v187
    v_mfma_f32_16x16x32_bf16 v[72:75], v[44:47], a[120:123], v[72:75]
    s_waitcnt vmcnt(10)
    v_cmp_ne_u32 vcc, s81, v23
    s_nop 0
    s_cbranch_vccnz L_slow_f3
L_ok_f3:
    s_waitcnt lgkmcnt(0)
    s_barrier
    buffer_load_dwordx4 v[240:243], v2, s[28:31], s80 offen offset:1024 sc1
    v_mfma_f32_16x16x32_bf16 v[80:83], v[48:51], a[120:123], v[80:83]
    s_nop 0
    ds_read_b128 v[40:43], v19 offset:12288
    ds_read_b128 v[56:59], v17 offset:16384
    v_mfma_f32_16x16x32_bf16 v[84:87], v[48:51], a[124:127], v[84:87]
    s_nop 0
    ds_read_b128 v[44:47], v20 offset:12288
    ds_read_b128 v[48:51], v21 offset:12288
    v_mfma_f32_16x16x32_bf16 v[92:95], v[52:55], a[124:127], v[92:95]
    buffer_load_dwordx4 v[244:247], v2, s[28:31], s80 offen offset:2048 sc1
    v_mfma_f32_16x16x32_bf16 v[88:91], v[52:55], a[120:123], v[88:91]
    s_waitcnt lgkmcnt(3)
    ds_read_b128 v[52:55], v22 offset:12288
    v_exp_f32 v176, v176
    v_mfma_f32_16x16x32_bf16 v[64:67], v[40:43], a[128:131], v[64:67]
    s_add_u32 s79, s49, 0
    buffer_load_dwordx4 a[0:3], v2, s[28:31], s79 offen sc1
    v_mfma_f32_16x16x32_bf16 v[68:71], v[40:43], a[132:135], v[68:71]
    s_waitcnt lgkmcnt(3)
    buffer_load_dwordx4 a[4:7], v2, s[28:31], s79 offen offset:1024 sc1
    v_mfma_f32_16x16x32_bf16 v[96:99], v[40:43], v[56:59], v[96:99]
    s_waitcnt lgkmcnt(2)
    ds_read_b128 v[40:43], v19 offset:28672
    ds_read_b128 v[56:59], v18 offset:16384
    v_mfma_f32_16x16x32_bf16 v[76:79], v[44:47], a[132:135], v[76:79]
    buffer_load_dwordx4 v[248:251], v2, s[28:31], s80 offen offset:3072 sc1
    v_exp_f32 v188, v188
    v_mfma_f32_16x16x32_bf16 v[72:75], v[44:47], a[128:131], v[72:75]
    s_waitcnt lgkmcnt(3)
    ds_read_b128 v[44:47], v20 offset:28672
    v_exp_f32 v177, v177
    v_mfma_f32_16x16x32_bf16 v[80:83], v[48:51], a[128:131], v[80:83]
    buffer_load_dwordx4 v[252:255], v3, s[28:31], s80 offen sc1
    v_mfma_f32_16x16x32_bf16 v[84:87], v[48:51], a[132:135], v[84:87]
    s_waitcnt lgkmcnt(3)
    ds_read_b128 v[48:51], v21 offset:28672
    v_exp_f32 v189, v189
    v_mfma_f32_16x16x32_bf16 v[92:95], v[52:55], a[132:135], v[92:95]
    buffer_load_dwordx4 a[8:11], v2, s[28:31], s79 offen offset:2048 sc1
    v_mfma_f32_16x16x32_bf16 v[88:91], v[52:55], a[128:131], v[88:91]
    s_waitcnt lgkmcnt(2)
    ds_read_b128 v[52:55], v22 offset:28672
    v_exp_f32 v178, v178
    v_mfma_f32_16x16x32_bf16 v[64:67], v[40:43], a[136:139], v[64:67]
    v_exp_f32 v190, v190
    v_mfma_f32_16x16x32_bf16 v[68:71], v[40:43], a[140:143], v[68:71]
    v_exp_f32 v179, v179
    v_mfma_f32_16x16x32_bf16 v[96:99], v[40:43], v[56:59], v[96:99]
    s_waitcnt lgkmcnt(2)
    ds_read_b128 v[40:43], v19 offset:45056
    ds_read_b128 v[56:59], v17 offset:18432
    v_exp_f32 v191, v191
    v_mfma_f32_16x16x32_bf16 v[76:79], v[44:47], a[140:143], v[76:79]
    buffer_load_dwordx4 a[12:15], v2, s[28:31], s79 offen offset:3072 sc1
    v_cvt_pk_bf16_f32 v144, v172, v173
    v_mfma_f32_16x16x32_bf16 v[72:75], v[44:47], a[136:139], v[72:75]
    s_waitcnt lgkmcnt(3)
    ds_read_b128 v[44:47], v20 offset:45056
    v_cvt_pk_bf16_f32 v160, v184, v185
    v_cvt_pk_bf16_f32 v145, v174, v175
    v_mfma_f32_16x16x32_bf16 v[80:83], v[48:51], a[136:139], v[80:83]
    v_cvt_pk_bf16_f32 v161, v186, v187
    v_cvt_pk_bf16_f32 v146, v176, v177
    v_cvt_pk_bf16_f32 v162, v188, v189
    v_mfma_f32_16x16x32_bf16 v[84:87], v[48:51], a[140:143], v[84:87]
    ds_read_b128 v[48:51], v21 offset:45056
    v_cvt_pk_bf16_f32 v147, v178, v179
    v_cvt_pk_bf16_f32 v163, v190, v191
    s_nop 0
    v_mfma_f32_16x16x32_bf16 v[148:151], a[240:243], v[144:147], 0
    s_waitcnt lgkmcnt(4)
    v_mfma_f32_16x16x32_bf16 v[92:95], v[52:55], a[140:143], v[92:95]
    s_add_u32 s79, s49, 0x1000
    buffer_load_dwordx4 a[16:19], v2, s[28:31], s79 offen sc1
    v_mfma_f32_16x16x32_bf16 v[164:167], a[240:243], v[160:163], 0
    v_mfma_f32_16x16x32_bf16 v[88:91], v[52:55], a[136:139], v[88:91]
    ds_read_b128 v[52:55], v22 offset:45056
    v_mfma_f32_16x16x32_bf16 v[172:175], v[136:139], v[144:147], 0
    s_waitcnt lgkmcnt(2)
    v_mfma_f32_16x16x32_bf16 v[64:67], v[40:43], a[144:147], v[64:67]
    v_mfma_f32_16x16x32_bf16 v[184:187], v[152:155], v[160:163], 0
    v_mfma_f32_16x16x32_bf16 v[68:71], v[40:43], a[148:151], v[68:71]
    v_mfma_f32_16x16x32_bf16 v[176:179], v[140:143], v[144:147], 0
    v_mfma_f32_16x16x32_bf16 v[96:99], v[40:43], v[56:59], v[96:99]
    s_nop 0
    ds_read_b128 v[40:43], v19 offset:61440
    ds_read_b128 v[56:59], v18 offset:18432
    v_mfma_f32_16x16x32_bf16 v[188:191], v[156:159], v[160:163], 0
    v_mfma_f32_16x16x32_bf16 v[76:79], v[44:47], a[148:151], v[76:79]
    buffer_load_dwordx4 a[20:23], v2, s[28:31], s79 offen offset:1024 sc1
    v_mfma_f32_16x16x32_bf16 v[72:75], v[44:47], a[144:147], v[72:75]
    s_waitcnt lgkmcnt(2)
    ds_read_b128 v[44:47], v20 offset:61440
    v_mfma_f32_16x16x32_bf16 v[80:83], v[48:51], a[144:147], v[80:83]
    v_rcp_f32 v180, v148
    v_mfma_f32_16x16x32_bf16 v[84:87], v[48:51], a[148:151], v[84:87]
    ds_read_b128 v[48:51], v21 offset:61440
    v_rcp_f32 v192, v164
    v_mfma_f32_16x16x32_bf16 v[92:95], v[52:55], a[148:151], v[92:95]
    v_mul_f32 v172, v172, v180
    v_mul_f32 v184, v184, v192
    v_mul_f32 v173, v173, v180
    v_mfma_f32_16x16x32_bf16 v[88:91], v[52:55], a[144:147], v[88:91]
    s_waitcnt lgkmcnt(2)
    ds_read_b128 v[52:55], v22 offset:61440
    v_mul_f32 v185, v185, v192
    v_mul_f32 v174, v174, v180
    v_mfma_f32_16x16x32_bf16 v[64:67], v[40:43], a[152:155], v[64:67]
    buffer_load_dwordx4 a[24:27], v2, s[28:31], s79 offen offset:2048 sc1
    v_mul_f32 v186, v186, v192
    v_mul_f32 v175, v175, v180
    v_mfma_f32_16x16x32_bf16 v[68:71], v[40:43], a[156:159], v[68:71]
    v_mul_f32 v187, v187, v192
    v_mul_f32 v176, v176, v180
    v_mul_f32 v188, v188, v192
    v_mfma_f32_16x16x32_bf16 v[96:99], v[40:43], v[56:59], v[96:99]
    s_waitcnt lgkmcnt(2)
    v_mul_f32 v177, v177, v180
    v_mul_f32 v189, v189, v192
    v_mul_f32 v178, v178, v180
    v_mfma_f32_16x16x32_bf16 v[76:79], v[44:47], a[156:159], v[76:79]
    v_mul_f32 v190, v190, v192
    v_mul_f32 v179, v179, v180
    v_mul_f32 v191, v191, v192
    v_mfma_f32_16x16x32_bf16 v[72:75], v[44:47], a[152:155], v[72:75]
    s_waitcnt lgkmcnt(1)
    buffer_load_dwordx4 a[28:31], v2, s[28:31], s79 offen offset:3072 sc1
    v_cvt_pk_bf16_f32 v112, v172, v173
    v_mfma_f32_16x16x32_bf16 v[80:83], v[48:51], a[152:155], v[80:83]
    v_cvt_pk_bf16_f32 v120, v184, v185
    v_cvt_pk_bf16_f32 v113, v174, v175
    v_cvt_pk_bf16_f32 v121, v186, v187
    v_mfma_f32_16x16x32_bf16 v[84:87], v[48:51], a[156:159], v[84:87]
    s_waitcnt lgkmcnt(0)
    v_cvt_pk_bf16_f32 v116, v176, v177
    v_cvt_pk_bf16_f32 v124, v188, v189
    v_cvt_pk_bf16_f32 v117, v178, v179
    v_mfma_f32_16x16x32_bf16 v[92:95], v[52:55], a[156:159], v[92:95]
    v_cvt_pk_bf16_f32 v125, v190, v191
    v_mfma_f32_16x16x32_bf16 v[88:91], v[52:55], a[152:155], v[88:91]
    s_mov_b64 exec, s[70:71]
    ds_write_b128 v7, v[96:99] offset:256
    s_mov_b64 exec, -1
    v_mul_f32 v190, v28, v30
    v_mul_f32 v191, v29, v31
    v_pk_mul_f32 v[64:65], v[64:65], v[30:31] op_sel:[0,0] op_sel_hi:[1,0]
    v_pk_mul_f32 v[66:67], v[66:67], v[30:31] op_sel:[0,0] op_sel_hi:[1,0]
    v_pk_mul_f32 v[68:69], v[68:69], v[30:31] op_sel:[0,1] op_sel_hi:[1,1]
    v_pk_mul_f32 v[70:71], v[70:71], v[30:31] op_sel:[0,1] op_sel_hi:[1,1]
    v_pk_mul_f32 v[72:73], v[72:73], v[30:31] op_sel:[0,0] op_sel_hi:[1,0]
    s_add_u32 s79, s49, 0x2000
    buffer_load_dwordx4 a[32:35], v2, s[28:31], s79 offen sc1
    v_pk_mul_f32 v[74:75], v[74:75], v[30:31] op_sel:[0,0] op_sel_hi:[1,0]
    v_pk_mul_f32 v[76:77], v[76:77], v[30:31] op_sel:[0,1] op_sel_hi:[1,1]
    v_pk_mul_f32 v[78:79], v[78:79], v[30:31] op_sel:[0,1] op_sel_hi:[1,1]
    v_pk_mul_f32 v[80:81], v[80:81], v[30:31] op_sel:[0,0] op_sel_hi:[1,0]
    v_pk_mul_f32 v[82:83], v[82:83], v[30:31] op_sel:[0,0] op_sel_hi:[1,0]
    v_pk_mul_f32 v[84:85], v[84:85], v[30:31] op_sel:[0,1] op_sel_hi:[1,1]
    v_pk_mul_f32 v[86:87], v[86:87], v[30:31] op_sel:[0,1] op_sel_hi:[1,1]
    v_pk_mul_f32 v[88:89], v[88:89], v[30:31] op_sel:[0,0] op_sel_hi:[1,0]
    buffer_load_dwordx4 a[36:39], v2, s[28:31], s79 offen offset:1024 sc1
    v_pk_mul_f32 v[90:91], v[90:91], v[30:31] op_sel:[0,0] op_sel_hi:[1,0]
    v_pk_mul_f32 v[92:93], v[92:93], v[30:31] op_sel:[0,1] op_sel_hi:[1,1]
    v_pk_mul_f32 v[94:95], v[94:95], v[30:31] op_sel:[0,1] op_sel_hi:[1,1]
    s_waitcnt lgkmcnt(0)
    s_barrier
    s_add_u32 s56, s32, 0
    s_and_b32 s56, s56, 3
    s_lshl_b32 s56, s56, 6
    s_add_u32 s56, s56, 0x27300
    buffer_load_dwordx4 a[40:43], v2, s[28:31], s79 offen offset:2048 sc1
    v_add_u32 v192, s56, v6
    ds_read_b128 v[172:175], v192
    s_add_u32 s56, s32, 1
    s_and_b32 s56, s56, 3
    s_lshl_b32 s56, s56, 6
    s_add_u32 s56, s56, 0x27300
    v_add_u32 v192, s56, v6
    ds_read_b128 v[176:179], v192
    buffer_load_dwordx4 a[44:47], v2, s[28:31], s79 offen offset:3072 sc1
    s_add_u32 s56, s32, 2
    s_and_b32 s56, s56, 3
    s_lshl_b32 s56, s56, 6
    s_add_u32 s56, s56, 0x27300
    v_add_u32 v192, s56, v6
    ds_read_b128 v[180:183], v192
    s_add_u32 s56, s32, 3
    s_and_b32 s56, s56, 3
    s_add_u32 s79, s49, 0x3000
    buffer_load_dwordx4 a[48:51], v2, s[28:31], s79 offen sc1
    s_lshl_b32 s56, s56, 6
    s_add_u32 s56, s56, 0x27300
    v_add_u32 v192, s56, v6
    ds_read_b128 v[184:187], v192
    s_waitcnt lgkmcnt(3)
    v_fma_f32 v96, -v61, v172, v96
    v_fma_f32 v97, -v61, v173, v97
    v_fma_f32 v98, -v61, v174, v98
    v_fma_f32 v99, -v61, v175, v99
    buffer_load_dwordx4 a[52:55], v2, s[28:31], s79 offen offset:1024 sc1
    v_mul_f32 v96, v96, v62
    v_mul_f32 v97, v97, v62
    v_mul_f32 v98, v98, v62
    v_mul_f32 v99, v99, v62
    v_cvt_pk_bf16_f32 v188, v96, v97
    v_cvt_pk_bf16_f32 v189, v98, v99
    ds_write_b64 v12, v[188:189] offset:19584
    v_pk_fma_f32 v[64:65], v[172:173], v[190:191], v[64:65] op_sel:[0,0,0] op_sel_hi:[1,0,1] neg_lo:[1,0,0] neg_hi:[1,0,0]
    buffer_load_dwordx4 a[56:59], v2, s[28:31], s79 offen offset:2048 sc1
    v_pk_fma_f32 v[66:67], v[174:175], v[190:191], v[66:67] op_sel:[0,0,0] op_sel_hi:[1,0,1] neg_lo:[1,0,0] neg_hi:[1,0,0]
    v_cvt_pk_bf16_f32 v64, v64, v65
    v_cvt_pk_bf16_f32 v65, v66, v67
    ds_write_b64 v8, v[64:65] offset:19584
    v_pk_fma_f32 v[68:69], v[172:173], v[190:191], v[68:69] op_sel:[0,1,0] op_sel_hi:[1,1,1] neg_lo:[1,0,0] neg_hi:[1,0,0]
    v_pk_fma_f32 v[70:71], v[174:175], v[190:191], v[70:71] op_sel:[0,1,0] op_sel_hi:[1,1,1] neg_lo:[1,0,0] neg_hi:[1,0,0]
    v_cvt_pk_bf16_f32 v68, v68, v69
    v_cvt_pk_bf16_f32 v69, v70, v71
    buffer_load_dwordx4 a[60:63], v2, s[28:31], s79 offen offset:3072 sc1
    ds_write_b64 v8, v[68:69] offset:29376
    s_waitcnt lgkmcnt(5)
    v_pk_fma_f32 v[72:73], v[176:177], v[190:191], v[72:73] op_sel:[0,0,0] op_sel_hi:[1,0,1] neg_lo:[1,0,0] neg_hi:[1,0,0]
    v_pk_fma_f32 v[74:75], v[178:179], v[190:191], v[74:75] op_sel:[0,0,0] op_sel_hi:[1,0,1] neg_lo:[1,0,0] neg_hi:[1,0,0]
    v_cvt_pk_bf16_f32 v72, v72, v73
    v_cvt_pk_bf16_f32 v73, v74, v75
    ds_write_b64 v9, v[72:73] offset:19584
    v_pk_fma_f32 v[76:77], v[176:177], v[190:191], v[76:77] op_sel:[0,1,0] op_sel_hi:[1,1,1] neg_lo:[1,0,0] neg_hi:[1,0,0]
    v_pk_fma_f32 v[78:79], v[178:179], v[190:191], v[78:79] op_sel:[0,1,0] op_sel_hi:[1,1,1] neg_lo:[1,0,0] neg_hi:[1,0,0]
    s_add_u32 s79, s49, 0x4000
    buffer_load_dwordx4 a[64:67], v2, s[28:31], s79 offen sc1
    v_cvt_pk_bf16_f32 v76, v76, v77
    v_cvt_pk_bf16_f32 v77, v78, v79
    ds_write_b64 v9, v[76:77] offset:29376
    s_waitcnt lgkmcnt(6)
    v_pk_fma_f32 v[80:81], v[180:181], v[190:191], v[80:81] op_sel:[0,0,0] op_sel_hi:[1,0,1] neg_lo:[1,0,0] neg_hi:[1,0,0]
    v_pk_fma_f32 v[82:83], v[182:183], v[190:191], v[82:83] op_sel:[0,0,0] op_sel_hi:[1,0,1] neg_lo:[1,0,0] neg_hi:[1,0,0]
    v_cvt_pk_bf16_f32 v80, v80, v81
    v_cvt_pk_bf16_f32 v81, v82, v83
    ds_write_b64 v10, v[80:81] offset:19584
    buffer_load_dwordx4 a[68:71], v2, s[28:31], s79 offen offset:1024 sc1
    v_pk_fma_f32 v[84:85], v[180:181], v[190:191], v[84:85] op_sel:[0,1,0] op_sel_hi:[1,1,1] neg_lo:[1,0,0] neg_hi:[1,0,0]
    v_pk_fma_f32 v[86:87], v[182:183], v[190:191], v[86:87] op_sel:[0,1,0] op_sel_hi:[1,1,1] neg_lo:[1,0,0] neg_hi:[1,0,0]
    v_cvt_pk_bf16_f32 v84, v84, v85
    v_cvt_pk_bf16_f32 v85, v86, v87
    ds_write_b64 v10, v[84:85] offset:29376
    s_waitcnt lgkmcnt(7)
    v_pk_fma_f32 v[88:89], v[184:185], v[190:191], v[88:89] op_sel:[0,0,0] op_sel_hi:[1,0,1] neg_lo:[1,0,0] neg_hi:[1,0,0]
    v_pk_fma_f32 v[90:91], v[186:187], v[190:191], v[90:91] op_sel:[0,0,0] op_sel_hi:[1,0,1] neg_lo:[1,0,0] neg_hi:[1,0,0]
    v_cvt_pk_bf16_f32 v88, v88, v89
    buffer_load_dwordx4 a[72:75], v2, s[28:31], s79 offen offset:2048 sc1
    v_cvt_pk_bf16_f32 v89, v90, v91
    ds_write_b64 v11, v[88:89] offset:19584
    v_pk_fma_f32 v[92:93], v[184:185], v[190:191], v[92:93] op_sel:[0,1,0] op_sel_hi:[1,1,1] neg_lo:[1,0,0] neg_hi:[1,0,0]
    v_pk_fma_f32 v[94:95], v[186:187], v[190:191], v[94:95] op_sel:[0,1,0] op_sel_hi:[1,1,1] neg_lo:[1,0,0] neg_hi:[1,0,0]
    v_cvt_pk_bf16_f32 v92, v92, v93
    v_cvt_pk_bf16_f32 v93, v94, v95
    ds_write_b64 v11, v[92:93] offset:29376
    s_waitcnt lgkmcnt(0)
    s_barrier
    buffer_load_dwordx4 a[76:79], v2, s[28:31], s79 offen offset:3072 sc1
    v_add_u32 v183, 0x4c80, v5
    v_add_u32 v195, 0x72c0, v5
    v_cndmask_b32 v182, v5, v183, s[0:1]
    v_cndmask_b32 v194, v5, v195, s[0:1]
    ds_read_b64 v[72:73], v4 offset:19584
    ds_read_b64 v[88:89], v4 offset:29376
    ds_read_b64 v[74:75], v182
    ds_read_b64 v[90:91], v194
    s_add_u32 s79, s49, 0x5000
    buffer_load_dwordx4 a[80:83], v2, s[28:31], s79 offen sc1
    ds_read_b64 v[64:65], v13 offset:19584
    ds_read_b64 v[80:81], v13 offset:29376
    ds_read_b64 v[66:67], v14 offset:19584
    ds_read_b64 v[82:83], v14 offset:29376
    ds_read_b64 v[68:69], v13 offset:20672
    ds_read_b64 v[84:85], v13 offset:30464
    ds_read_b64 v[70:71], v14 offset:20672
    ds_read_b64 v[86:87], v14 offset:30464
    buffer_load_dwordx4 a[84:87], v2, s[28:31], s79 offen offset:1024 sc1
    s_waitcnt lgkmcnt(5)
    v_mfma_f32_16x16x32_bf16 v[172:175], v[64:67], v[72:75], v[32:35]
    s_waitcnt lgkmcnt(4)
    v_mfma_f32_16x16x32_bf16 v[184:187], v[80:83], v[88:91], v[32:35]
    s_waitcnt lgkmcnt(1)
    v_mfma_f32_16x16x32_bf16 v[176:179], v[68:71], v[72:75], v[36:39]
    s_waitcnt lgkmcnt(0)
    v_mfma_f32_16x16x32_bf16 v[188:191], v[84:87], v[88:91], v[36:39]
    ds_read_b64_tr_b16 v[64:65], v15 offset:19584
    ds_read_b64_tr_b16 v[80:81], v15 offset:29376
    ds_read_b64_tr_b16 v[68:69], v16 offset:19584
    ds_read_b64_tr_b16 v[84:85], v16 offset:29376
    buffer_load_dwordx4 a[88:91], v2, s[28:31], s79 offen offset:2048 sc1
    ds_read_b64_tr_b16 v[66:67], v15 offset:20672
    ds_read_b64_tr_b16 v[82:83], v15 offset:30464
    ds_read_b64_tr_b16 v[70:71], v16 offset:20672
    ds_read_b64_tr_b16 v[86:87], v16 offset:30464
    v_max3_f32 v180, v172, v173, v174
    v_max3_f32 v192, v184, v185, v186
    v_max3_f32 v181, v175, v176, v177
    v_max3_f32 v193, v187, v188, v189
    buffer_load_dwordx4 a[92:95], v2, s[28:31], s79 offen offset:3072 sc1
    v_max3_f32 v180, v180, v178, v179
    v_max3_f32 v192, v192, v190, v191
    v_max_f32 v180, v180, v181
    v_max_f32 v192, v192, v193
    v_mov_b32 v181, v180
    v_mov_b32 v193, v192
    s_nop 0
    v_permlane16_swap_b32 v180, v181
    v_permlane16_swap_b32 v192, v193
    s_add_u32 s79, s49, 0x6000
    buffer_load_dwordx4 a[96:99], v2, s[28:31], s79 offen sc1
    v_max_f32 v180, v180, v181
    v_max_f32 v192, v192, v193
    v_mov_b32 v181, v180
    v_mov_b32 v193, v192
    s_nop 0
    v_permlane32_swap_b32 v180, v181
    v_permlane32_swap_b32 v192, v193
    v_max_f32 v180, v180, v181
    v_max_f32 v192, v192, v193
    buffer_load_dwordx4 a[100:103], v2, s[28:31], s79 offen offset:1024 sc1
    v_mul_f32 v180, s78, v180
    v_mul_f32 v192, s78, v192
    v_fma_f32 v172, v172, s78, -v180
    v_fma_f32 v184, v184, s78, -v192
    v_fma_f32 v173, v173, s78, -v180
    v_fma_f32 v185, v185, s78, -v192
    v_fma_f32 v174, v174, s78, -v180
    v_fma_f32 v186, v186, s78, -v192
    buffer_load_dwordx4 a[104:107], v2, s[28:31], s79 offen offset:2048 sc1
    v_fma_f32 v175, v175, s78, -v180
    v_fma_f32 v187, v187, s78, -v192
    v_fma_f32 v176, v176, s78, -v180
    v_fma_f32 v188, v188, s78, -v192
    v_fma_f32 v177, v177, s78, -v180
    v_fma_f32 v189, v189, s78, -v192
    v_fma_f32 v178, v178, s78, -v180
    v_fma_f32 v190, v190, s78, -v192
    buffer_load_dwordx4 a[108:111], v2, s[28:31], s79 offen offset:3072 sc1
    v_fma_f32 v179, v179, s78, -v180
    v_fma_f32 v191, v191, s78, -v192
    v_exp_f32 v172, v172
    v_exp_f32 v184, v184
    v_exp_f32 v173, v173
    v_exp_f32 v185, v185
    v_exp_f32 v174, v174
    v_exp_f32 v186, v186
    s_add_u32 s79, s49, 0x7000
    buffer_load_dwordx4 a[112:115], v2, s[28:31], s79 offen sc1
    v_exp_f32 v175, v175
    v_exp_f32 v187, v187
    v_exp_f32 v176, v176
    v_exp_f32 v188, v188
    v_exp_f32 v177, v177
    v_exp_f32 v189, v189
    v_exp_f32 v178, v178
    v_exp_f32 v190, v190
    buffer_load_dwordx4 a[116:119], v2, s[28:31], s79 offen offset:1024 sc1
    v_exp_f32 v179, v179
    v_exp_f32 v191, v191
    v_cvt_pk_bf16_f32 v72, v172, v173
    v_cvt_pk_bf16_f32 v88, v184, v185
    v_cvt_pk_bf16_f32 v73, v174, v175
    v_cvt_pk_bf16_f32 v89, v186, v187
    v_cvt_pk_bf16_f32 v74, v176, v177
    v_cvt_pk_bf16_f32 v90, v188, v189
    buffer_load_dwordx4 a[120:123], v2, s[28:31], s79 offen offset:2048 sc1
    v_cvt_pk_bf16_f32 v75, v178, v179
    v_cvt_pk_bf16_f32 v91, v190, v191
    s_nop 0
    v_mfma_f32_16x16x32_bf16 v[76:79], a[240:243], v[72:75], 0
    v_mfma_f32_16x16x32_bf16 v[92:95], a[240:243], v[88:91], 0
    s_waitcnt lgkmcnt(3)
    v_mfma_f32_16x16x32_bf16 v[172:175], v[64:67], v[72:75], 0
    s_waitcnt lgkmcnt(2)
    v_mfma_f32_16x16x32_bf16 v[184:187], v[80:83], v[88:91], 0
    s_waitcnt lgkmcnt(1)
    v_mfma_f32_16x16x32_bf16 v[176:179], v[68:71], v[72:75], 0
    s_waitcnt lgkmcnt(0)
    v_mfma_f32_16x16x32_bf16 v[188:191], v[84:87], v[88:91], 0
    buffer_load_dwordx4 a[124:127], v2, s[28:31], s79 offen offset:3072 sc1
    v_rcp_f32 v180, v76
    v_rcp_f32 v192, v92
    v_mul_f32 v172, v172, v180
    v_mul_f32 v184, v184, v192
    v_mul_f32 v173, v173, v180
    v_mul_f32 v185, v185, v192
    v_mul_f32 v174, v174, v180
    v_mul_f32 v186, v186, v192
    s_add_u32 s79, s49, 0x8000
    buffer_load_dwordx4 a[128:131], v2, s[28:31], s79 offen sc1
    v_mul_f32 v175, v175, v180
    v_mul_f32 v187, v187, v192
    v_mul_f32 v176, v176, v180
    v_mul_f32 v188, v188, v192
    v_mul_f32 v177, v177, v180
    v_mul_f32 v189, v189, v192
    v_mul_f32 v178, v178, v180
    v_mul_f32 v190, v190, v192
    buffer_load_dwordx4 a[132:135], v2, s[28:31], s79 offen offset:1024 sc1
    v_mul_f32 v179, v179, v180
    v_mul_f32 v191, v191, v192
    v_cvt_pk_bf16_f32 v114, v172, v173
    v_cvt_pk_bf16_f32 v122, v184, v185
    v_cvt_pk_bf16_f32 v115, v174, v175
    v_cvt_pk_bf16_f32 v123, v186, v187
    v_cvt_pk_bf16_f32 v118, v176, v177
    v_cvt_pk_bf16_f32 v126, v188, v189
    buffer_load_dwordx4 a[136:139], v2, s[28:31], s79 offen offset:2048 sc1
    v_cvt_pk_bf16_f32 v119, v178, v179
    v_cvt_pk_bf16_f32 v127, v190, v191
    buffer_load_dwordx4 a[140:143], v2, s[28:31], s79 offen offset:3072 sc1
    buffer_store_dwordx4 v[112:115], v2, s[28:31], s47 offen sc1
    buffer_store_dwordx4 v[120:123], v2, s[28:31], s47 offen offset:1024 sc1
    v_cndmask_b32 v116, v124, v116, s[0:1]
    v_cndmask_b32 v117, v125, v117, s[0:1]
    v_cndmask_b32 v118, v126, v118, s[0:1]
    v_cndmask_b32 v119, v127, v119, s[0:1]
    buffer_store_dwordx4 v[116:119], v63, s[28:31], s48 offen sc1
    s_lshl_b32 s56, s33, 1
    s_lshr_b32 s57, s32, 1
    s_add_u32 s56, s56, s57
    s_lshl_b32 s56, s56, 7
    s_and_b32 s57, s32, 1
    s_lshl1_add_u32 s57, s34, s57
    s_lshl2_add_u32 s56, s57, s56
    s_add_u32 s56, s56, 0x2800
    v_mov_b32 v194, s56
    v_mov_b32 v195, 0x7ffffff0
    v_cmp_eq_u32 s[92:93], 0, v1
    s_nop 1
    v_cndmask_b32 v25, v195, v194, s[92:93]
    s_lshl_b32 s96, s35, 7
    s_add_u32 s96, s96, 0x2800
    s_cmp_eq_u32 s32, 0
    s_cselect_b32 s96, s96, 0x7ffffff0
    v_and_b32 v173, 31, v1
    v_lshl_add_u32 v24, v173, 2, s96
    s_waitcnt vmcnt(40)
    v_mfma_f32_16x16x32_bf16 v[40:43], a[160:163], a[0:3], 0
    s_waitcnt vmcnt(39)
    v_mfma_f32_16x16x32_bf16 v[44:47], a[160:163], a[4:7], 0
    s_waitcnt vmcnt(36)
    v_mfma_f32_16x16x32_bf16 v[48:51], a[160:163], a[8:11], 0
    s_waitcnt vmcnt(35)
    v_mfma_f32_16x16x32_bf16 v[52:55], a[160:163], a[12:15], 0
    s_add_u32 s80, s52, 0x8c00
    buffer_load_dwordx4 a[160:163], v2, s[28:31], s80 offen sc1
    v_mfma_f32_16x16x32_bf16 v[68:71], a[164:167], a[12:15], 0
    v_mfma_f32_16x16x32_bf16 v[64:67], a[164:167], a[8:11], 0
    v_mfma_f32_16x16x32_bf16 v[60:63], a[164:167], a[4:7], 0
    v_mfma_f32_16x16x32_bf16 v[56:59], a[164:167], a[0:3], 0
    buffer_load_dwordx4 a[164:167], v2, s[28:31], s80 offen offset:1024 sc1
    v_mfma_f32_16x16x32_bf16 v[72:75], a[168:171], a[0:3], 0
    v_mfma_f32_16x16x32_bf16 v[76:79], a[168:171], a[4:7], 0
    v_mfma_f32_16x16x32_bf16 v[80:83], a[168:171], a[8:11], 0
    v_mfma_f32_16x16x32_bf16 v[84:87], a[168:171], a[12:15], 0
    buffer_load_dwordx4 a[168:171], v2, s[28:31], s80 offen offset:2048 sc1
    v_mfma_f32_16x16x32_bf16 v[100:103], a[172:175], a[12:15], 0
    v_mfma_f32_16x16x32_bf16 v[96:99], a[172:175], a[8:11], 0
    v_mfma_f32_16x16x32_bf16 v[92:95], a[172:175], a[4:7], 0
    v_mfma_f32_16x16x32_bf16 v[88:91], a[172:175], a[0:3], 0
    buffer_load_dwordx4 a[172:175], v2, s[28:31], s80 offen offset:3072 sc1
    v_mfma_f32_16x16x32_bf16 v[104:107], a[176:179], a[0:3], 0
    v_mfma_f32_16x16x32_bf16 v[108:111], a[176:179], a[4:7], 0
    v_mfma_f32_16x16x32_bf16 v[112:115], a[176:179], a[8:11], 0
    v_mfma_f32_16x16x32_bf16 v[116:119], a[176:179], a[12:15], 0
    s_waitcnt vmcnt(38)
    buffer_load_dwordx4 a[176:179], v3, s[28:31], s80 offen sc1
    v_mfma_f32_16x16x32_bf16 v[40:43], a[180:183], a[16:19], v[40:43]
    s_waitcnt vmcnt(38)
    v_mfma_f32_16x16x32_bf16 v[44:47], a[180:183], a[20:23], v[44:47]
    s_waitcnt vmcnt(37)
    v_mfma_f32_16x16x32_bf16 v[48:51], a[180:183], a[24:27], v[48:51]
    s_waitcnt vmcnt(36)
    v_mfma_f32_16x16x32_bf16 v[52:55], a[180:183], a[28:31], v[52:55]
    s_add_u32 s80, s52, 0xa000
    buffer_load_dwordx4 a[180:183], v2, s[28:31], s80 offen sc1
    v_mfma_f32_16x16x32_bf16 v[68:71], a[184:187], a[28:31], v[68:71]
    v_mfma_f32_16x16x32_bf16 v[64:67], a[184:187], a[24:27], v[64:67]
    v_mfma_f32_16x16x32_bf16 v[60:63], a[184:187], a[20:23], v[60:63]
    v_mfma_f32_16x16x32_bf16 v[56:59], a[184:187], a[16:19], v[56:59]
    buffer_load_dwordx4 a[184:187], v2, s[28:31], s80 offen offset:1024 sc1
    v_mfma_f32_16x16x32_bf16 v[72:75], a[188:191], a[16:19], v[72:75]
    v_mfma_f32_16x16x32_bf16 v[76:79], a[188:191], a[20:23], v[76:79]
    v_mfma_f32_16x16x32_bf16 v[80:83], a[188:191], a[24:27], v[80:83]
    v_mfma_f32_16x16x32_bf16 v[84:87], a[188:191], a[28:31], v[84:87]
    buffer_load_dwordx4 a[188:191], v2, s[28:31], s80 offen offset:2048 sc1
    v_mfma_f32_16x16x32_bf16 v[100:103], a[192:195], a[28:31], v[100:103]
    v_mfma_f32_16x16x32_bf16 v[96:99], a[192:195], a[24:27], v[96:99]
    v_mfma_f32_16x16x32_bf16 v[92:95], a[192:195], a[20:23], v[92:95]
    v_mfma_f32_16x16x32_bf16 v[88:91], a[192:195], a[16:19], v[88:91]
    buffer_load_dwordx4 a[192:195], v2, s[28:31], s80 offen offset:3072 sc1
    v_mfma_f32_16x16x32_bf16 v[104:107], a[196:199], a[16:19], v[104:107]
    v_mfma_f32_16x16x32_bf16 v[108:111], a[196:199], a[20:23], v[108:111]
    v_mfma_f32_16x16x32_bf16 v[112:115], a[196:199], a[24:27], v[112:115]
    v_mfma_f32_16x16x32_bf16 v[116:119], a[196:199], a[28:31], v[116:119]
    s_waitcnt vmcnt(39)
    buffer_load_dwordx4 a[196:199], v3, s[28:31], s80 offen sc1
    v_mfma_f32_16x16x32_bf16 v[40:43], a[200:203], a[32:35], v[40:43]
    s_waitcnt vmcnt(39)
    v_mfma_f32_16x16x32_bf16 v[44:47], a[200:203], a[36:39], v[44:47]
    s_waitcnt vmcnt(38)
    v_mfma_f32_16x16x32_bf16 v[48:51], a[200:203], a[40:43], v[48:51]
    s_waitcnt vmcnt(37)
    v_mfma_f32_16x16x32_bf16 v[52:55], a[200:203], a[44:47], v[52:55]
    s_add_u32 s80, s52, 0xb400
    buffer_load_dwordx4 a[200:203], v2, s[28:31], s80 offen sc1
    v_mfma_f32_16x16x32_bf16 v[68:71], a[204:207], a[44:47], v[68:71]
    v_mfma_f32_16x16x32_bf16 v[64:67], a[204:207], a[40:43], v[64:67]
    s_mul_i32 s56, s35, 0x14000
    s_mul_i32 s57, s36, 0xa0
    s_add_u32 s58, s56, s57
    v_mfma_f32_16x16x32_bf16 v[60:63], a[204:207], a[36:39], v[60:63]
    v_add_u32 v142, 0, v0
    v_mul_u32_u24 v143, 0x667, v142
    v_mfma_f32_16x16x32_bf16 v[56:59], a[204:207], a[32:35], v[56:59]
    buffer_load_dwordx4 a[204:207], v2, s[28:31], s80 offen offset:1024 sc1
    v_mfma_f32_16x16x32_bf16 v[72:75], a[208:211], a[32:35], v[72:75]
    v_lshrrev_b32 v143, 15, v143
    v_mul_u32_u24 v144, 20, v143
    v_mfma_f32_16x16x32_bf16 v[76:79], a[208:211], a[36:39], v[76:79]
    v_sub_u32 v144, v142, v144
    v_mul_u32_u24 v148, 0x500, v143
    v_mfma_f32_16x16x32_bf16 v[80:83], a[208:211], a[40:43], v[80:83]
    v_lshl_add_u32 v148, v144, 3, v148
    v_and_b32 v142, 1, v143
    v_mfma_f32_16x16x32_bf16 v[84:87], a[208:211], a[44:47], v[84:87]
    buffer_load_dwordx4 a[208:211], v2, s[28:31], s80 offen offset:2048 sc1
    v_mfma_f32_16x16x32_bf16 v[100:103], a[212:215], a[44:47], v[100:103]
    v_lshlrev_b32 v142, 4, v142
    v_and_b32 v153, 32, v143
    v_mfma_f32_16x16x32_bf16 v[96:99], a[212:215], a[40:43], v[96:99]
    v_add_u32 v142, v142, v153
    v_bfe_u32 v153, v143, 1, 4
    v_mfma_f32_16x16x32_bf16 v[92:95], a[212:215], a[36:39], v[92:95]
    v_add_u32 v142, v142, v153
    v_and_b32 v143, 48, v142
    v_mfma_f32_16x16x32_bf16 v[88:91], a[212:215], a[32:35], v[88:91]
    buffer_load_dwordx4 a[212:215], v2, s[28:31], s80 offen offset:3072 sc1
    v_mfma_f32_16x16x32_bf16 v[104:107], a[216:219], a[32:35], v[104:107]
    v_mul_u32_u24 v142, 0x150, v142
    v_lshl_add_u32 v142, v143, 2, v142
    v_mfma_f32_16x16x32_bf16 v[108:111], a[216:219], a[36:39], v[108:111]
    v_lshl_add_u32 v153, v144, 4, v142
    v_add_u32 v142, 0x100, v0
    v_mfma_f32_16x16x32_bf16 v[112:115], a[216:219], a[40:43], v[112:115]
    v_mul_u32_u24 v143, 0x667, v142
    v_lshrrev_b32 v143, 15, v143
    v_mfma_f32_16x16x32_bf16 v[116:119], a[216:219], a[44:47], v[116:119]
    s_waitcnt vmcnt(40)
    buffer_load_dwordx4 a[216:219], v3, s[28:31], s80 offen sc1
    v_mfma_f32_16x16x32_bf16 v[40:43], a[220:223], a[48:51], v[40:43]
    s_waitcnt vmcnt(15)
    buffer_store_dword v27, v25, s[28:31], 0 offen sc1
    v_mfma_f32_16x16x32_bf16 v[44:47], a[220:223], a[52:55], v[44:47]
    v_mul_u32_u24 v144, 20, v143
    v_sub_u32 v144, v142, v144
    v_mfma_f32_16x16x32_bf16 v[48:51], a[220:223], a[56:59], v[48:51]
    s_add_u32 s79, s49, 0x9000
    buffer_load_dwordx4 a[144:147], v2, s[28:31], s79 offen sc1
    v_mfma_f32_16x16x32_bf16 v[52:55], a[220:223], a[60:63], v[52:55]
    v_mul_u32_u24 v149, 0x500, v143
    v_lshl_add_u32 v149, v144, 3, v149
    v_mfma_f32_16x16x32_bf16 v[68:71], a[224:227], a[60:63], v[68:71]
    v_and_b32 v142, 1, v143
    v_lshlrev_b32 v142, 4, v142
    v_mfma_f32_16x16x32_bf16 v[64:67], a[224:227], a[56:59], v[64:67]
    v_and_b32 v154, 32, v143
    v_add_u32 v142, v142, v154
    v_mfma_f32_16x16x32_bf16 v[60:63], a[224:227], a[52:55], v[60:63]
    buffer_load_dwordx4 a[148:151], v2, s[28:31], s79 offen offset:1024 sc1
    v_mfma_f32_16x16x32_bf16 v[56:59], a[224:227], a[48:51], v[56:59]
    v_bfe_u32 v154, v143, 1, 4
    v_add_u32 v142, v142, v154
    v_mfma_f32_16x16x32_bf16 v[72:75], a[228:231], a[48:51], v[72:75]
    v_and_b32 v143, 48, v142
    v_mul_u32_u24 v142, 0x150, v142
    v_mfma_f32_16x16x32_bf16 v[76:79], a[228:231], a[52:55], v[76:79]
    buffer_load_dwordx4 a[152:155], v2, s[28:31], s79 offen offset:2048 sc1
    v_mfma_f32_16x16x32_bf16 v[80:83], a[228:231], a[56:59], v[80:83]
    v_lshl_add_u32 v142, v143, 2, v142
    v_lshl_add_u32 v154, v144, 4, v142
    v_mfma_f32_16x16x32_bf16 v[84:87], a[228:231], a[60:63], v[84:87]
    v_add_u32 v142, 0x200, v0
    v_mul_u32_u24 v143, 0x667, v142
    v_mfma_f32_16x16x32_bf16 v[100:103], a[232:235], a[60:63], v[100:103]
    v_lshrrev_b32 v143, 15, v143
    v_mul_u32_u24 v144, 20, v143
    v_mfma_f32_16x16x32_bf16 v[96:99], a[232:235], a[56:59], v[96:99]
    buffer_load_dwordx4 a[156:159], v2, s[28:31], s79 offen offset:3072 sc1
    v_mfma_f32_16x16x32_bf16 v[92:95], a[232:235], a[52:55], v[92:95]
    v_sub_u32 v144, v142, v144
    v_mul_u32_u24 v150, 0x500, v143
    v_mfma_f32_16x16x32_bf16 v[88:91], a[232:235], a[48:51], v[88:91]
    v_lshl_add_u32 v150, v144, 3, v150
    v_and_b32 v142, 1, v143
    v_mfma_f32_16x16x32_bf16 v[104:107], a[236:239], a[48:51], v[104:107]
    s_add_u32 s80, s52, 0xc800
    buffer_load_dwordx4 a[220:223], v2, s[28:31], s80 offen sc1
    v_mfma_f32_16x16x32_bf16 v[108:111], a[236:239], a[52:55], v[108:111]
    v_lshlrev_b32 v142, 4, v142
    v_and_b32 v155, 32, v143
    v_mfma_f32_16x16x32_bf16 v[112:115], a[236:239], a[56:59], v[112:115]
    v_add_u32 v142, v142, v155
    v_bfe_u32 v155, v143, 1, 4
    v_mfma_f32_16x16x32_bf16 v[116:119], a[236:239], a[60:63], v[116:119]
    v_add_u32 v142, v142, v155
    v_and_b32 v143, 48, v142
    v_mfma_f32_16x16x32_bf16 v[40:43], v[196:199], a[64:67], v[40:43]
    buffer_load_dwordx4 a[224:227], v2, s[28:31], s80 offen offset:1024 sc1
    v_mfma_f32_16x16x32_bf16 v[44:47], v[196:199], a[68:71], v[44:47]
    v_mul_u32_u24 v142, 0x150, v142
    v_lshl_add_u32 v142, v143, 2, v142
    v_mfma_f32_16x16x32_bf16 v[48:51], v[196:199], a[72:75], v[48:51]
    v_lshl_add_u32 v155, v144, 4, v142
    v_add_u32 v142, 0x300, v0
    v_mfma_f32_16x16x32_bf16 v[52:55], v[196:199], a[76:79], v[52:55]
    buffer_load_dwordx4 a[228:231], v2, s[28:31], s80 offen offset:2048 sc1
    v_mfma_f32_16x16x32_bf16 v[68:71], v[200:203], a[76:79], v[68:71]
    v_mul_u32_u24 v143, 0x667, v142
    v_lshrrev_b32 v143, 15, v143
    v_mfma_f32_16x16x32_bf16 v[64:67], v[200:203], a[72:75], v[64:67]
    v_mul_u32_u24 v144, 20, v143
    v_sub_u32 v144, v142, v144
    v_mfma_f32_16x16x32_bf16 v[60:63], v[200:203], a[68:71], v[60:63]
    v_mul_u32_u24 v151, 0x500, v143
    v_lshl_add_u32 v151, v144, 3, v151
    v_mfma_f32_16x16x32_bf16 v[56:59], v[200:203], a[64:67], v[56:59]
    buffer_load_dwordx4 a[232:235], v2, s[28:31], s80 offen offset:3072 sc1
    v_mfma_f32_16x16x32_bf16 v[72:75], v[204:207], a[64:67], v[72:75]
    v_and_b32 v142, 1, v143
    v_lshlrev_b32 v142, 4, v142
    v_mfma_f32_16x16x32_bf16 v[76:79], v[204:207], a[68:71], v[76:79]
    v_and_b32 v156, 32, v143
    v_add_u32 v142, v142, v156
    v_mfma_f32_16x16x32_bf16 v[80:83], v[204:207], a[72:75], v[80:83]
    buffer_load_dwordx4 a[236:239], v3, s[28:31], s80 offen sc1
    v_mfma_f32_16x16x32_bf16 v[84:87], v[204:207], a[76:79], v[84:87]
    v_bfe_u32 v156, v143, 1, 4
    v_add_u32 v142, v142, v156
    v_mfma_f32_16x16x32_bf16 v[100:103], v[208:211], a[76:79], v[100:103]
    v_and_b32 v143, 48, v142
    v_mul_u32_u24 v142, 0x150, v142
    v_mfma_f32_16x16x32_bf16 v[96:99], v[208:211], a[72:75], v[96:99]
    v_lshl_add_u32 v142, v143, 2, v142
    v_lshl_add_u32 v156, v144, 4, v142
    v_mfma_f32_16x16x32_bf16 v[92:95], v[208:211], a[68:71], v[92:95]
    s_add_u32 s79, s49, 0xa000
    buffer_load_dwordx4 a[0:3], v2, s[28:31], s79 offen sc1
    v_mfma_f32_16x16x32_bf16 v[88:91], v[208:211], a[64:67], v[88:91]
    v_add_u32 v142, 0x400, v0
    v_mul_u32_u24 v143, 0x667, v142
    v_mfma_f32_16x16x32_bf16 v[104:107], v[212:215], a[64:67], v[104:107]
    v_lshrrev_b32 v143, 15, v143
    v_mul_u32_u24 v144, 20, v143
    v_mfma_f32_16x16x32_bf16 v[108:111], v[212:215], a[68:71], v[108:111]
    v_sub_u32 v144, v142, v144
    v_mul_u32_u24 v152, 0x500, v143
    v_mfma_f32_16x16x32_bf16 v[112:115], v[212:215], a[72:75], v[112:115]
    buffer_load_dwordx4 a[4:7], v2, s[28:31], s79 offen offset:1024 sc1
    v_mfma_f32_16x16x32_bf16 v[116:119], v[212:215], a[76:79], v[116:119]
    v_lshl_add_u32 v152, v144, 3, v152
    v_and_b32 v142, 1, v143
    v_mfma_f32_16x16x32_bf16 v[40:43], v[216:219], a[80:83], v[40:43]
    v_lshlrev_b32 v142, 4, v142
    v_and_b32 v157, 32, v143
    v_mfma_f32_16x16x32_bf16 v[44:47], v[216:219], a[84:87], v[44:47]
    buffer_load_dwordx4 a[8:11], v2, s[28:31], s79 offen offset:2048 sc1
    v_mfma_f32_16x16x32_bf16 v[48:51], v[216:219], a[88:91], v[48:51]
    v_add_u32 v142, v142, v157
    v_bfe_u32 v157, v143, 1, 4
    v_mfma_f32_16x16x32_bf16 v[52:55], v[216:219], a[92:95], v[52:55]
    v_add_u32 v142, v142, v157
    v_and_b32 v143, 48, v142
    v_mfma_f32_16x16x32_bf16 v[68:71], v[220:223], a[92:95], v[68:71]
    v_mul_u32_u24 v142, 0x150, v142
    v_lshl_add_u32 v142, v143, 2, v142
    v_mfma_f32_16x16x32_bf16 v[64:67], v[220:223], a[88:91], v[64:67]
    buffer_load_dwordx4 a[12:15], v2, s[28:31], s79 offen offset:3072 sc1
    v_mfma_f32_16x16x32_bf16 v[60:63], v[220:223], a[84:87], v[60:63]
    v_lshl_add_u32 v157, v144, 4, v142
    v_and_b32 v142, 15, v1
    v_mfma_f32_16x16x32_bf16 v[56:59], v[220:223], a[80:83], v[56:59]
    v_mul_u32_u24 v142, 0x150, v142
    v_lshrrev_b32 v143, 4, v1
    v_mfma_f32_16x16x32_bf16 v[72:75], v[224:227], a[80:83], v[72:75]
    s_add_u32 s80, s52, 0xdc00
    buffer_load_dwordx4 v[196:199], v2, s[28:31], s80 offen sc1
    v_mfma_f32_16x16x32_bf16 v[76:79], v[224:227], a[84:87], v[76:79]
    s_mul_i32 s56, s32, 0x5500
    v_lshl_add_u32 v142, v143, 4, v142
    v_add_u32 v146, s56, v142
    v_mfma_f32_16x16x32_bf16 v[80:83], v[224:227], a[88:91], v[80:83]
    v_mov_b32 v142, 0x7ffffff0
    v_or_b32 v143, s2, v0
    v_mfma_f32_16x16x32_bf16 v[84:87], v[224:227], a[92:95], v[84:87]
    v_cmp_ne_u32 s[92:93], 0, v143
    v_mfma_f32_16x16x32_bf16 v[100:103], v[228:231], a[92:95], v[100:103]
    buffer_load_dwordx4 v[200:203], v2, s[28:31], s80 offen offset:1024 sc1
    v_mfma_f32_16x16x32_bf16 v[96:99], v[228:231], a[88:91], v[96:99]
    v_cndmask_b32 v142, 0, v142, s[92:93]
    v_mfma_f32_16x16x32_bf16 v[92:95], v[228:231], a[84:87], v[92:95]
    buffer_store_dword v27, v142, s[28:31], 0 offen sc1
    v_mfma_f32_16x16x32_bf16 v[88:91], v[228:231], a[80:83], v[88:91]
    buffer_load_dwordx4 v[204:207], v2, s[28:31], s80 offen offset:2048 sc1
    v_mfma_f32_16x16x32_bf16 v[104:107], v[232:235], a[80:83], v[104:107]
    v_mfma_f32_16x16x32_bf16 v[108:111], v[232:235], a[84:87], v[108:111]
    v_mfma_f32_16x16x32_bf16 v[112:115], v[232:235], a[88:91], v[112:115]
    v_mfma_f32_16x16x32_bf16 v[116:119], v[232:235], a[92:95], v[116:119]
    buffer_load_dwordx4 v[208:211], v2, s[28:31], s80 offen offset:3072 sc1
    v_mfma_f32_16x16x32_bf16 v[40:43], v[236:239], a[96:99], v[40:43]
    v_mfma_f32_16x16x32_bf16 v[44:47], v[236:239], a[100:103], v[44:47]
    v_mfma_f32_16x16x32_bf16 v[48:51], v[236:239], a[104:107], v[48:51]
    buffer_load_dwordx4 v[212:215], v3, s[28:31], s80 offen sc1
    v_mfma_f32_16x16x32_bf16 v[52:55], v[236:239], a[108:111], v[52:55]
    v_mfma_f32_16x16x32_bf16 v[68:71], v[240:243], a[108:111], v[68:71]
    v_mfma_f32_16x16x32_bf16 v[64:67], v[240:243], a[104:107], v[64:67]
    v_mfma_f32_16x16x32_bf16 v[60:63], v[240:243], a[100:103], v[60:63]
    s_add_u32 s79, s49, 0xb000
    buffer_load_dwordx4 a[16:19], v2, s[28:31], s79 offen sc1
    v_mfma_f32_16x16x32_bf16 v[56:59], v[240:243], a[96:99], v[56:59]
    v_mfma_f32_16x16x32_bf16 v[72:75], v[244:247], a[96:99], v[72:75]
    v_mfma_f32_16x16x32_bf16 v[76:79], v[244:247], a[100:103], v[76:79]
    v_mfma_f32_16x16x32_bf16 v[80:83], v[244:247], a[104:107], v[80:83]
    buffer_load_dwordx4 a[20:23], v2, s[28:31], s79 offen offset:1024 sc1
    v_mfma_f32_16x16x32_bf16 v[84:87], v[244:247], a[108:111], v[84:87]
    v_mfma_f32_16x16x32_bf16 v[100:103], v[248:251], a[108:111], v[100:103]
    v_mfma_f32_16x16x32_bf16 v[96:99], v[248:251], a[104:107], v[96:99]
    buffer_load_dwordx4 a[24:27], v2, s[28:31], s79 offen offset:2048 sc1
    v_mfma_f32_16x16x32_bf16 v[92:95], v[248:251], a[100:103], v[92:95]
    v_mfma_f32_16x16x32_bf16 v[88:91], v[248:251], a[96:99], v[88:91]
    v_mfma_f32_16x16x32_bf16 v[104:107], v[252:255], a[96:99], v[104:107]
    v_mfma_f32_16x16x32_bf16 v[108:111], v[252:255], a[100:103], v[108:111]
    buffer_load_dwordx4 a[28:31], v2, s[28:31], s79 offen offset:3072 sc1
    v_mfma_f32_16x16x32_bf16 v[112:115], v[252:255], a[104:107], v[112:115]
    v_mfma_f32_16x16x32_bf16 v[116:119], v[252:255], a[108:111], v[116:119]
    s_waitcnt vmcnt(38)
    v_mfma_f32_16x16x32_bf16 v[40:43], a[160:163], a[112:115], v[40:43]
    s_add_u32 s80, s53, 0
    buffer_load_dwordx4 v[216:219], v2, s[28:31], s80 offen sc1
    v_mfma_f32_16x16x32_bf16 v[44:47], a[160:163], a[116:119], v[44:47]
    buffer_load_dword v23, v24, s[28:31], 0 offen sc1
    v_mfma_f32_16x16x32_bf16 v[48:51], a[160:163], a[120:123], v[48:51]
    v_mfma_f32_16x16x32_bf16 v[52:55], a[160:163], a[124:127], v[52:55]
    s_waitcnt vmcnt(39)
    v_mfma_f32_16x16x32_bf16 v[68:71], a[164:167], a[124:127], v[68:71]
    buffer_load_dwordx4 v[220:223], v2, s[28:31], s80 offen offset:1024 sc1
    v_mfma_f32_16x16x32_bf16 v[64:67], a[164:167], a[120:123], v[64:67]
    v_mfma_f32_16x16x32_bf16 v[60:63], a[164:167], a[116:119], v[60:63]
    v_mfma_f32_16x16x32_bf16 v[56:59], a[164:167], a[112:115], v[56:59]
    s_waitcnt vmcnt(39)
    buffer_load_dwordx4 v[224:227], v2, s[28:31], s80 offen offset:2048 sc1
    v_mfma_f32_16x16x32_bf16 v[72:75], a[168:171], a[112:115], v[72:75]
    v_mfma_f32_16x16x32_bf16 v[76:79], a[168:171], a[116:119], v[76:79]
    v_mfma_f32_16x16x32_bf16 v[80:83], a[168:171], a[120:123], v[80:83]
    v_mfma_f32_16x16x32_bf16 v[84:87], a[168:171], a[124:127], v[84:87]
    s_waitcnt vmcnt(39)
    buffer_load_dwordx4 v[228:231], v2, s[28:31], s80 offen offset:3072 sc1
    v_mfma_f32_16x16x32_bf16 v[100:103], a[172:175], a[124:127], v[100:103]
    v_mfma_f32_16x16x32_bf16 v[96:99], a[172:175], a[120:123], v[96:99]
    v_mfma_f32_16x16x32_bf16 v[92:95], a[172:175], a[116:119], v[92:95]
    buffer_load_dwordx4 v[232:235], v3, s[28:31], s80 offen sc1
    v_mfma_f32_16x16x32_bf16 v[88:91], a[172:175], a[112:115], v[88:91]
    s_waitcnt vmcnt(40)
    v_mfma_f32_16x16x32_bf16 v[104:107], a[176:179], a[112:115], v[104:107]
    v_mfma_f32_16x16x32_bf16 v[108:111], a[176:179], a[116:119], v[108:111]
    v_mfma_f32_16x16x32_bf16 v[112:115], a[176:179], a[120:123], v[112:115]
    s_add_u32 s80, s53, 0x1400
    buffer_load_dwordx4 v[236:239], v2, s[28:31], s80 offen sc1
    v_mfma_f32_16x16x32_bf16 v[116:119], a[176:179], a[124:127], v[116:119]
    s_waitcnt vmcnt(40)
    v_mfma_f32_16x16x32_bf16 v[40:43], a[180:183], a[128:131], v[40:43]
    v_mfma_f32_16x16x32_bf16 v[44:47], a[180:183], a[132:135], v[44:47]
    buffer_load_dwordx4 v[240:243], v2, s[28:31], s80 offen offset:1024 sc1
    v_mfma_f32_16x16x32_bf16 v[48:51], a[180:183], a[136:139], v[48:51]
    v_mfma_f32_16x16x32_bf16 v[52:55], a[180:183], a[140:143], v[52:55]
    s_waitcnt vmcnt(40)
    v_mfma_f32_16x16x32_bf16 v[68:71], a[184:187], a[140:143], v[68:71]
    v_mfma_f32_16x16x32_bf16 v[64:67], a[184:187], a[136:139], v[64:67]
    buffer_load_dwordx4 v[244:247], v2, s[28:31], s80 offen offset:2048 sc1
    v_mfma_f32_16x16x32_bf16 v[60:63], a[184:187], a[132:135], v[60:63]
    v_mfma_f32_16x16x32_bf16 v[56:59], a[184:187], a[128:131], v[56:59]
    s_waitcnt vmcnt(40)
    v_mfma_f32_16x16x32_bf16 v[72:75], a[188:191], a[128:131], v[72:75]
    v_mfma_f32_16x16x32_bf16 v[76:79], a[188:191], a[132:135], v[76:79]
    buffer_load_dwordx4 v[248:251], v2, s[28:31], s80 offen offset:3072 sc1
    v_mfma_f32_16x16x32_bf16 v[80:83], a[188:191], a[136:139], v[80:83]
    v_mfma_f32_16x16x32_bf16 v[84:87], a[188:191], a[140:143], v[84:87]
    s_waitcnt vmcnt(40)
    v_mfma_f32_16x16x32_bf16 v[100:103], a[192:195], a[140:143], v[100:103]
    buffer_load_dwordx4 v[252:255], v3, s[28:31], s80 offen sc1
    v_mfma_f32_16x16x32_bf16 v[96:99], a[192:195], a[136:139], v[96:99]
    v_mfma_f32_16x16x32_bf16 v[92:95], a[192:195], a[132:135], v[92:95]
    v_mfma_f32_16x16x32_bf16 v[88:91], a[192:195], a[128:131], v[88:91]
    s_waitcnt vmcnt(40)
    v_mfma_f32_16x16x32_bf16 v[104:107], a[196:199], a[128:131], v[104:107]
    s_add_u32 s80, s53, 0x2800
    buffer_load_dwordx4 a[160:163], v2, s[28:31], s80 offen sc1
    v_mfma_f32_16x16x32_bf16 v[108:111], a[196:199], a[132:135], v[108:111]
    v_mfma_f32_16x16x32_bf16 v[112:115], a[196:199], a[136:139], v[112:115]
    v_mfma_f32_16x16x32_bf16 v[116:119], a[196:199], a[140:143], v[116:119]
    s_waitcnt vmcnt(34)
    buffer_load_dwordx4 a[164:167], v2, s[28:31], s80 offen offset:1024 sc1
    v_mfma_f32_16x16x32_bf16 v[40:43], a[200:203], a[144:147], v[40:43]
    s_waitcnt vmcnt(34)
    v_mfma_f32_16x16x32_bf16 v[44:47], a[200:203], a[148:151], v[44:47]
    s_waitcnt vmcnt(33)
    v_mfma_f32_16x16x32_bf16 v[48:51], a[200:203], a[152:155], v[48:51]
    s_waitcnt vmcnt(32)
    v_mfma_f32_16x16x32_bf16 v[52:55], a[200:203], a[156:159], v[52:55]
    buffer_load_dwordx4 a[168:171], v2, s[28:31], s80 offen offset:2048 sc1
    v_mfma_f32_16x16x32_bf16 v[68:71], a[204:207], a[156:159], v[68:71]
    v_mfma_f32_16x16x32_bf16 v[64:67], a[204:207], a[152:155], v[64:67]
    v_mfma_f32_16x16x32_bf16 v[60:63], a[204:207], a[148:151], v[60:63]
    buffer_load_dwordx4 a[172:175], v2, s[28:31], s80 offen offset:3072 sc1
    v_mfma_f32_16x16x32_bf16 v[56:59], a[204:207], a[144:147], v[56:59]
    v_mfma_f32_16x16x32_bf16 v[72:75], a[208:211], a[144:147], v[72:75]
    v_mfma_f32_16x16x32_bf16 v[76:79], a[208:211], a[148:151], v[76:79]
    v_mfma_f32_16x16x32_bf16 v[80:83], a[208:211], a[152:155], v[80:83]
    buffer_load_dwordx4 a[176:179], v3, s[28:31], s80 offen sc1
    v_mfma_f32_16x16x32_bf16 v[84:87], a[208:211], a[156:159], v[84:87]
    v_mfma_f32_16x16x32_bf16 v[100:103], a[212:215], a[156:159], v[100:103]
    v_mfma_f32_16x16x32_bf16 v[96:99], a[212:215], a[152:155], v[96:99]
    s_add_u32 s80, s53, 0x3c00
    buffer_load_dwordx4 a[180:183], v2, s[28:31], s80 offen sc1
    v_mfma_f32_16x16x32_bf16 v[92:95], a[212:215], a[148:151], v[92:95]
    v_mfma_f32_16x16x32_bf16 v[88:91], a[212:215], a[144:147], v[88:91]
    v_mfma_f32_16x16x32_bf16 v[104:107], a[216:219], a[144:147], v[104:107]
    v_mfma_f32_16x16x32_bf16 v[108:111], a[216:219], a[148:151], v[108:111]
    buffer_load_dwordx4 a[184:187], v2, s[28:31], s80 offen offset:1024 sc1
    v_mfma_f32_16x16x32_bf16 v[112:115], a[216:219], a[152:155], v[112:115]
    v_mfma_f32_16x16x32_bf16 v[116:119], a[216:219], a[156:159], v[116:119]
    s_waitcnt vmcnt(16)
    v_cmp_ne_u32 vcc, s81, v23
    s_nop 0
    s_cbranch_vccnz L_slow_f4
L_ok_f4:
    s_barrier
    v_mfma_f32_16x16x32_bf16 v[40:43], a[220:223], a[0:3], v[40:43]
    v_mfma_f32_16x16x32_bf16 v[44:47], a[220:223], a[4:7], v[44:47]
    buffer_load_dwordx4 a[188:191], v2, s[28:31], s80 offen offset:2048 sc1
    v_mfma_f32_16x16x32_bf16 v[48:51], a[220:223], a[8:11], v[48:51]
    v_mfma_f32_16x16x32_bf16 v[52:55], a[220:223], a[12:15], v[52:55]
    v_mfma_f32_16x16x32_bf16 v[68:71], a[224:227], a[12:15], v[68:71]
    buffer_load_dwordx4 a[192:195], v2, s[28:31], s80 offen offset:3072 sc1
    v_mfma_f32_16x16x32_bf16 v[64:67], a[224:227], a[8:11], v[64:67]
    v_mfma_f32_16x16x32_bf16 v[60:63], a[224:227], a[4:7], v[60:63]
    v_mfma_f32_16x16x32_bf16 v[56:59], a[224:227], a[0:3], v[56:59]
    v_mfma_f32_16x16x32_bf16 v[72:75], a[228:231], a[0:3], v[72:75]
    buffer_load_dwordx4 a[196:199], v3, s[28:31], s80 offen sc1
    v_mfma_f32_16x16x32_bf16 v[76:79], a[228:231], a[4:7], v[76:79]
    v_mfma_f32_16x16x32_bf16 v[80:83], a[228:231], a[8:11], v[80:83]
    v_mfma_f32_16x16x32_bf16 v[84:87], a[228:231], a[12:15], v[84:87]
    s_add_u32 s79, s50, 0
    buffer_load_dwordx4 a[32:35], v2, s[28:31], s79 offen sc1
    v_mfma_f32_16x16x32_bf16 v[100:103], a[232:235], a[12:15], v[100:103]
    v_mfma_f32_16x16x32_bf16 v[96:99], a[232:235], a[8:11], v[96:99]
    v_mfma_f32_16x16x32_bf16 v[92:95], a[232:235], a[4:7], v[92:95]
    v_mfma_f32_16x16x32_bf16 v[88:91], a[232:235], a[0:3], v[88:91]
    buffer_load_dwordx4 a[36:39], v2, s[28:31], s79 offen offset:1024 sc1
    v_mfma_f32_16x16x32_bf16 v[104:107], a[236:239], a[0:3], v[104:107]
    v_mfma_f32_16x16x32_bf16 v[108:111], a[236:239], a[4:7], v[108:111]
    v_mfma_f32_16x16x32_bf16 v[112:115], a[236:239], a[8:11], v[112:115]
    buffer_load_dwordx4 a[40:43], v2, s[28:31], s79 offen offset:2048 sc1
    v_mfma_f32_16x16x32_bf16 v[116:119], a[236:239], a[12:15], v[116:119]
    v_mfma_f32_16x16x32_bf16 v[40:43], v[196:199], a[16:19], v[40:43]
    v_mfma_f32_16x16x32_bf16 v[44:47], v[196:199], a[20:23], v[44:47]
    v_mfma_f32_16x16x32_bf16 v[48:51], v[196:199], a[24:27], v[48:51]
    buffer_load_dwordx4 a[44:47], v2, s[28:31], s79 offen offset:3072 sc1
    v_mfma_f32_16x16x32_bf16 v[52:55], v[196:199], a[28:31], v[52:55]
    v_mfma_f32_16x16x32_bf16 v[68:71], v[200:203], a[28:31], v[68:71]
    v_mfma_f32_16x16x32_bf16 v[64:67], v[200:203], a[24:27], v[64:67]
    s_add_u32 s79, s50, 0x1000
    buffer_load_dwordx4 a[48:51], v2, s[28:31], s79 offen sc1
    v_mfma_f32_16x16x32_bf16 v[60:63], v[200:203], a[20:23], v[60:63]
    v_mfma_f32_16x16x32_bf16 v[56:59], v[200:203], a[16:19], v[56:59]
    v_mfma_f32_16x16x32_bf16 v[72:75], v[204:207], a[16:19], v[72:75]
    v_mfma_f32_16x16x32_bf16 v[76:79], v[204:207], a[20:23], v[76:79]
    buffer_load_dwordx4 a[52:55], v2, s[28:31], s79 offen offset:1024 sc1
    v_mfma_f32_16x16x32_bf16 v[80:83], v[204:207], a[24:27], v[80:83]
    v_mfma_f32_16x16x32_bf16 v[84:87], v[204:207], a[28:31], v[84:87]
    v_mfma_f32_16x16x32_bf16 v[100:103], v[208:211], a[28:31], v[100:103]
    v_mfma_f32_16x16x32_bf16 v[96:99], v[208:211], a[24:27], v[96:99]
    buffer_load_dwordx4 a[56:59], v2, s[28:31], s79 offen offset:2048 sc1
    v_mfma_f32_16x16x32_bf16 v[92:95], v[208:211], a[20:23], v[92:95]
    v_mfma_f32_16x16x32_bf16 v[88:91], v[208:211], a[16:19], v[88:91]
    v_mfma_f32_16x16x32_bf16 v[104:107], v[212:215], a[16:19], v[104:107]
    buffer_load_dwordx4 a[60:63], v2, s[28:31], s79 offen offset:3072 sc1
    v_mfma_f32_16x16x32_bf16 v[108:111], v[212:215], a[20:23], v[108:111]
    v_mfma_f32_16x16x32_bf16 v[112:115], v[212:215], a[24:27], v[112:115]
    v_mfma_f32_16x16x32_bf16 v[116:119], v[212:215], a[28:31], v[116:119]
    s_waitcnt vmcnt(7)
    v_mfma_f32_16x16x32_bf16 v[40:43], v[216:219], a[32:35], v[40:43]
    s_waitcnt vmcnt(6)
    s_add_u32 s79, s50, 0x2000
    buffer_load_dwordx4 a[64:67], v2, s[28:31], s79 offen sc1
    v_mfma_f32_16x16x32_bf16 v[44:47], v[216:219], a[36:39], v[44:47]
    s_waitcnt vmcnt(6)
    v_accvgpr_read_b32 v161, a244
    v_accvgpr_read_b32 v163, a245
    v_mfma_f32_16x16x32_bf16 v[48:51], v[216:219], a[40:43], v[48:51]
    s_waitcnt vmcnt(5)
    v_lshlrev_b32 v160, 16, v161
    v_and_b32 v161, 0xffff0000, v161
    v_mfma_f32_16x16x32_bf16 v[52:55], v[216:219], a[44:47], v[52:55]
    buffer_load_dwordx4 a[68:71], v2, s[28:31], s79 offen offset:1024 sc1
    v_mfma_f32_16x16x32_bf16 v[68:71], v[220:223], a[44:47], v[68:71]
    v_lshlrev_b32 v162, 16, v163
    v_and_b32 v163, 0xffff0000, v163
    v_mfma_f32_16x16x32_bf16 v[64:67], v[220:223], a[40:43], v[64:67]
    v_accvgpr_read_b32 v165, a246
    v_accvgpr_read_b32 v167, a247
    v_mfma_f32_16x16x32_bf16 v[60:63], v[220:223], a[36:39], v[60:63]
    v_lshlrev_b32 v164, 16, v165
    v_and_b32 v165, 0xffff0000, v165
    v_mfma_f32_16x16x32_bf16 v[56:59], v[220:223], a[32:35], v[56:59]
    buffer_load_dwordx4 a[72:75], v2, s[28:31], s79 offen offset:2048 sc1
    v_mfma_f32_16x16x32_bf16 v[72:75], v[224:227], a[32:35], v[72:75]
    v_lshlrev_b32 v166, 16, v167
    v_and_b32 v167, 0xffff0000, v167
    v_mfma_f32_16x16x32_bf16 v[76:79], v[224:227], a[36:39], v[76:79]
    v_accvgpr_read_b32 v169, a248
    v_accvgpr_read_b32 v171, a249
    v_mfma_f32_16x16x32_bf16 v[80:83], v[224:227], a[40:43], v[80:83]
    buffer_load_dwordx4 a[76:79], v2, s[28:31], s79 offen offset:3072 sc1
    v_mfma_f32_16x16x32_bf16 v[84:87], v[224:227], a[44:47], v[84:87]
    v_lshlrev_b32 v168, 16, v169
    v_and_b32 v169, 0xffff0000, v169
    v_mfma_f32_16x16x32_bf16 v[100:103], v[228:231], a[44:47], v[100:103]
    v_lshlrev_b32 v170, 16, v171
    v_and_b32 v171, 0xffff0000, v171
    v_mfma_f32_16x16x32_bf16 v[96:99], v[228:231], a[40:43], v[96:99]
    v_accvgpr_read_b32 v173, a250
    v_accvgpr_read_b32 v175, a251
    v_mfma_f32_16x16x32_bf16 v[92:95], v[228:231], a[36:39], v[92:95]
    s_add_u32 s79, s50, 0x3000
    buffer_load_dwordx4 a[80:83], v2, s[28:31], s79 offen sc1
    v_mfma_f32_16x16x32_bf16 v[88:91], v[228:231], a[32:35], v[88:91]
    v_lshlrev_b32 v172, 16, v173
    v_and_b32 v173, 0xffff0000, v173
    v_mfma_f32_16x16x32_bf16 v[104:107], v[232:235], a[32:35], v[104:107]
    v_lshlrev_b32 v174, 16, v175
    v_and_b32 v175, 0xffff0000, v175
    v_mfma_f32_16x16x32_bf16 v[108:111], v[232:235], a[36:39], v[108:111]
    buffer_load_dwordx4 a[84:87], v2, s[28:31], s79 offen offset:1024 sc1
    v_mfma_f32_16x16x32_bf16 v[112:115], v[232:235], a[40:43], v[112:115]
    v_accvgpr_read_b32 v177, a252
    v_accvgpr_read_b32 v179, a253
    v_mfma_f32_16x16x32_bf16 v[116:119], v[232:235], a[44:47], v[116:119]
    s_waitcnt vmcnt(9)
    v_lshlrev_b32 v176, 16, v177
    v_and_b32 v177, 0xffff0000, v177
    v_mfma_f32_16x16x32_bf16 v[40:43], v[236:239], a[48:51], v[40:43]
    s_waitcnt vmcnt(8)
    v_lshlrev_b32 v178, 16, v179
    v_and_b32 v179, 0xffff0000, v179
    v_mfma_f32_16x16x32_bf16 v[44:47], v[236:239], a[52:55], v[44:47]
    s_waitcnt vmcnt(7)
    buffer_load_dwordx4 a[88:91], v2, s[28:31], s79 offen offset:2048 sc1
    v_mfma_f32_16x16x32_bf16 v[48:51], v[236:239], a[56:59], v[48:51]
    s_waitcnt vmcnt(7)
    v_mfma_f32_16x16x32_bf16 v[52:55], v[236:239], a[60:63], v[52:55]
    v_mfma_f32_16x16x32_bf16 v[68:71], v[240:243], a[60:63], v[68:71]
    buffer_load_dwordx4 a[92:95], v2, s[28:31], s79 offen offset:3072 sc1
    v_mfma_f32_16x16x32_bf16 v[64:67], v[240:243], a[56:59], v[64:67]
    v_mfma_f32_16x16x32_bf16 v[60:63], v[240:243], a[52:55], v[60:63]
    v_mfma_f32_16x16x32_bf16 v[56:59], v[240:243], a[48:51], v[56:59]
    v_mfma_f32_16x16x32_bf16 v[72:75], v[244:247], a[48:51], v[72:75]
    s_add_u32 s80, s54, 0
    buffer_load_dwordx4 a[200:203], v2, s[28:31], s80 offen sc1
    v_mfma_f32_16x16x32_bf16 v[76:79], v[244:247], a[52:55], v[76:79]
    v_mfma_f32_16x16x32_bf16 v[80:83], v[244:247], a[56:59], v[80:83]
    v_mfma_f32_16x16x32_bf16 v[84:87], v[244:247], a[60:63], v[84:87]
    v_mfma_f32_16x16x32_bf16 v[100:103], v[248:251], a[60:63], v[100:103]
    buffer_load_dwordx4 a[204:207], v2, s[28:31], s80 offen offset:1024 sc1
    v_mfma_f32_16x16x32_bf16 v[96:99], v[248:251], a[56:59], v[96:99]
    v_mfma_f32_16x16x32_bf16 v[92:95], v[248:251], a[52:55], v[92:95]
    v_mfma_f32_16x16x32_bf16 v[88:91], v[248:251], a[48:51], v[88:91]
    buffer_load_dwordx4 a[208:211], v2, s[28:31], s80 offen offset:2048 sc1
    v_mfma_f32_16x16x32_bf16 v[104:107], v[252:255], a[48:51], v[104:107]
    v_mfma_f32_16x16x32_bf16 v[108:111], v[252:255], a[52:55], v[108:111]
    v_mfma_f32_16x16x32_bf16 v[112:115], v[252:255], a[56:59], v[112:115]
    v_mfma_f32_16x16x32_bf16 v[116:119], v[252:255], a[60:63], v[116:119]
    s_waitcnt vmcnt(10)
    buffer_load_dwordx4 a[212:215], v2, s[28:31], s80 offen offset:3072 sc1
    v_mfma_f32_16x16x32_bf16 v[40:43], a[160:163], a[64:67], v[40:43]
    s_waitcnt vmcnt(10)
    v_mfma_f32_16x16x32_bf16 v[44:47], a[160:163], a[68:71], v[44:47]
    s_waitcnt vmcnt(9)
    v_mfma_f32_16x16x32_bf16 v[48:51], a[160:163], a[72:75], v[48:51]
    s_waitcnt vmcnt(8)
    buffer_load_dwordx4 a[216:219], v3, s[28:31], s80 offen sc1
    v_mfma_f32_16x16x32_bf16 v[52:55], a[160:163], a[76:79], v[52:55]
    v_mfma_f32_16x16x32_bf16 v[68:71], a[164:167], a[76:79], v[68:71]
    v_mfma_f32_16x16x32_bf16 v[64:67], a[164:167], a[72:75], v[64:67]
    v_mfma_f32_16x16x32_bf16 v[60:63], a[164:167], a[68:71], v[60:63]
    s_add_u32 s79, s51, 0
    buffer_load_dwordx4 a[96:99], v2, s[28:31], s79 offen sc1
    v_mfma_f32_16x16x32_bf16 v[56:59], a[164:167], a[64:67], v[56:59]
    v_mfma_f32_16x16x32_bf16 v[72:75], a[168:171], a[64:67], v[72:75]
    v_mfma_f32_16x16x32_bf16 v[76:79], a[168:171], a[68:71], v[76:79]
    buffer_load_dwordx4 a[100:103], v2, s[28:31], s79 offen offset:1024 sc1
    v_mfma_f32_16x16x32_bf16 v[80:83], a[168:171], a[72:75], v[80:83]
    v_mfma_f32_16x16x32_bf16 v[84:87], a[168:171], a[76:79], v[84:87]
    v_mfma_f32_16x16x32_bf16 v[100:103], a[172:175], a[76:79], v[100:103]
    v_mfma_f32_16x16x32_bf16 v[96:99], a[172:175], a[72:75], v[96:99]
    buffer_load_dwordx4 a[104:107], v2, s[28:31], s79 offen offset:2048 sc1
    v_mfma_f32_16x16x32_bf16 v[92:95], a[172:175], a[68:71], v[92:95]
    v_mfma_f32_16x16x32_bf16 v[88:91], a[172:175], a[64:67], v[88:91]
    v_mfma_f32_16x16x32_bf16 v[104:107], a[176:179], a[64:67], v[104:107]
    buffer_load_dwordx4 a[108:111], v2, s[28:31], s79 offen offset:3072 sc1
    v_mfma_f32_16x16x32_bf16 v[108:111], a[176:179], a[68:71], v[108:111]
    v_mfma_f32_16x16x32_bf16 v[112:115], a[176:179], a[72:75], v[112:115]
    v_mfma_f32_16x16x32_bf16 v[116:119], a[176:179], a[76:79], v[116:119]
    s_waitcnt vmcnt(12)
    v_mfma_f32_16x16x32_bf16 v[40:43], a[180:183], a[80:83], v[40:43]
    s_waitcnt vmcnt(11)
    v_mfma_f32_16x16x32_bf16 v[44:47], a[180:183], a[84:87], v[44:47]
    s_waitcnt vmcnt(10)
    v_mfma_f32_16x16x32_bf16 v[48:51], a[180:183], a[88:91], v[48:51]
    s_waitcnt vmcnt(9)
    v_mfma_f32_16x16x32_bf16 v[52:55], a[180:183], a[92:95], v[52:55]
    v_mfma_f32_16x16x32_bf16 v[68:71], a[184:187], a[92:95], v[68:71]
    v_mfma_f32_16x16x32_bf16 v[64:67], a[184:187], a[88:91], v[64:67]
    v_mfma_f32_16x16x32_bf16 v[60:63], a[184:187], a[84:87], v[60:63]
    v_mfma_f32_16x16x32_bf16 v[56:59], a[184:187], a[80:83], v[56:59]
    v_mfma_f32_16x16x32_bf16 v[72:75], a[188:191], a[80:83], v[72:75]
    v_mfma_f32_16x16x32_bf16 v[76:79], a[188:191], a[84:87], v[76:79]
    v_mfma_f32_16x16x32_bf16 v[80:83], a[188:191], a[88:91], v[80:83]
    v_mfma_f32_16x16x32_bf16 v[84:87], a[188:191], a[92:95], v[84:87]
    v_mfma_f32_16x16x32_bf16 v[100:103], a[192:195], a[92:95], v[100:103]
    v_mfma_f32_16x16x32_bf16 v[96:99], a[192:195], a[88:91], v[96:99]
    v_mfma_f32_16x16x32_bf16 v[92:95], a[192:195], a[84:87], v[92:95]
    v_mfma_f32_16x16x32_bf16 v[88:91], a[192:195], a[80:83], v[88:91]
    v_mfma_f32_16x16x32_bf16 v[104:107], a[196:199], a[80:83], v[104:107]
    v_mfma_f32_16x16x32_bf16 v[108:111], a[196:199], a[84:87], v[108:111]
    v_mfma_f32_16x16x32_bf16 v[112:115], a[196:199], a[88:91], v[112:115]
    v_mfma_f32_16x16x32_bf16 v[116:119], a[196:199], a[92:95], v[116:119]
    s_waitcnt vmcnt(3)
    v_mfma_f32_16x16x32_bf16 v[40:43], a[200:203], a[96:99], v[40:43]
    v_mfma_f32_16x16x32_bf16 v[56:59], a[204:207], a[96:99], v[56:59]
    v_mfma_f32_16x16x32_bf16 v[72:75], a[208:211], a[96:99], v[72:75]
    v_mfma_f32_16x16x32_bf16 v[88:91], a[212:215], a[96:99], v[88:91]
    v_mfma_f32_16x16x32_bf16 v[104:107], a[216:219], a[96:99], v[104:107]
    s_waitcnt vmcnt(2)
    v_mfma_f32_16x16x32_bf16 v[44:47], a[200:203], a[100:103], v[44:47]
    s_nop 1
    ds_write_b128 v146, v[40:43]
    v_mfma_f32_16x16x32_bf16 v[60:63], a[204:207], a[100:103], v[60:63]
    ds_write_b128 v146, v[56:59] offset:64
    v_mfma_f32_16x16x32_bf16 v[76:79], a[208:211], a[100:103], v[76:79]
    ds_write_b128 v146, v[72:75] offset:128
    v_mfma_f32_16x16x32_bf16 v[92:95], a[212:215], a[100:103], v[92:95]
    ds_write_b128 v146, v[88:91] offset:192
    v_mfma_f32_16x16x32_bf16 v[108:111], a[216:219], a[100:103], v[108:111]
    s_waitcnt vmcnt(1)
    ds_write_b128 v146, v[104:107] offset:256
    v_mfma_f32_16x16x32_bf16 v[48:51], a[200:203], a[104:107], v[48:51]
    ds_write_b128 v146, v[44:47] offset:5440
    v_mfma_f32_16x16x32_bf16 v[64:67], a[204:207], a[104:107], v[64:67]
    ds_write_b128 v146, v[60:63] offset:5504
    v_mfma_f32_16x16x32_bf16 v[80:83], a[208:211], a[104:107], v[80:83]
    ds_write_b128 v146, v[76:79] offset:5568
    v_mfma_f32_16x16x32_bf16 v[96:99], a[212:215], a[104:107], v[96:99]
    ds_write_b128 v146, v[92:95] offset:5632
    v_mfma_f32_16x16x32_bf16 v[112:115], a[216:219], a[104:107], v[112:115]
    s_waitcnt vmcnt(0)
    ds_write_b128 v146, v[108:111] offset:5696
    v_mfma_f32_16x16x32_bf16 v[52:55], a[200:203], a[108:111], v[52:55]
    ds_write_b128 v146, v[48:51] offset:10880
    v_mfma_f32_16x16x32_bf16 v[68:71], a[204:207], a[108:111], v[68:71]
    ds_write_b128 v146, v[64:67] offset:10944
    v_mfma_f32_16x16x32_bf16 v[84:87], a[208:211], a[108:111], v[84:87]
    ds_write_b128 v146, v[80:83] offset:11008
    v_mfma_f32_16x16x32_bf16 v[100:103], a[212:215], a[108:111], v[100:103]
    ds_write_b128 v146, v[96:99] offset:11072
    v_mfma_f32_16x16x32_bf16 v[116:119], a[216:219], a[108:111], v[116:119]
    ds_write_b128 v146, v[112:115] offset:11136
    ds_write_b128 v146, v[52:55] offset:16320
    ds_write_b128 v146, v[68:71] offset:16384
    s_nop 0
    ds_write_b128 v146, v[84:87] offset:16448
    s_nop 0
    ds_write_b128 v146, v[100:103] offset:16512
    s_nop 0
    ds_write_b128 v146, v[116:119] offset:16576
    s_waitcnt lgkmcnt(0)
    s_barrier
    ds_read_b128 v[40:43], v153
    ds_read_b128 v[44:47], v153 offset:21760
    ds_read_b128 v[48:51], v153 offset:43520
    ds_read_b128 v[52:55], v153 offset:65280
    ds_read_b128 v[56:59], v154
    ds_read_b128 v[60:63], v154 offset:21760
    ds_read_b128 v[64:67], v154 offset:43520
    ds_read_b128 v[68:71], v154 offset:65280
    ds_read_b128 v[72:75], v155
    ds_read_b128 v[76:79], v155 offset:21760
    ds_read_b128 v[80:83], v155 offset:43520
    ds_read_b128 v[84:87], v155 offset:65280
    ds_read_b128 v[88:91], v156
    ds_read_b128 v[92:95], v156 offset:21760
    ds_read_b128 v[96:99], v156 offset:43520
    ds_read_b128 v[100:103], v156 offset:65280
    ds_read_b128 v[104:107], v157
    ds_read_b128 v[108:111], v157 offset:21760
    ds_read_b128 v[112:115], v157 offset:43520
    ds_read_b128 v[116:119], v157 offset:65280
    s_waitcnt lgkmcnt(15)
    v_pk_add_f32 v[40:41], v[40:41], v[44:45]
    v_pk_add_f32 v[42:43], v[42:43], v[46:47]
    v_pk_add_f32 v[48:49], v[48:49], v[52:53]
    v_pk_add_f32 v[50:51], v[50:51], v[54:55]
    v_pk_add_f32 v[40:41], v[40:41], v[160:161]
    v_pk_add_f32 v[42:43], v[42:43], v[162:163]
    v_pk_add_f32 v[40:41], v[40:41], v[48:49]
    v_pk_add_f32 v[42:43], v[42:43], v[50:51]
    v_cvt_pk_bf16_f32 v44, v40, v41
    v_cvt_pk_bf16_f32 v45, v42, v43
    buffer_store_dwordx2 v[44:45], v148, s[24:27], s58 offen
    s_waitcnt lgkmcnt(14)
    v_pk_add_f32 v[56:57], v[56:57], v[60:61]
    v_pk_add_f32 v[58:59], v[58:59], v[62:63]
    s_waitcnt lgkmcnt(12)
    v_pk_add_f32 v[64:65], v[64:65], v[68:69]
    v_pk_add_f32 v[66:67], v[66:67], v[70:71]
    v_pk_add_f32 v[56:57], v[56:57], v[164:165]
    v_pk_add_f32 v[58:59], v[58:59], v[166:167]
    v_pk_add_f32 v[56:57], v[56:57], v[64:65]
    v_pk_add_f32 v[58:59], v[58:59], v[66:67]
    v_cvt_pk_bf16_f32 v60, v56, v57
    v_cvt_pk_bf16_f32 v61, v58, v59
    buffer_store_dwordx2 v[60:61], v149, s[24:27], s58 offen
    s_waitcnt lgkmcnt(10)
    v_pk_add_f32 v[72:73], v[72:73], v[76:77]
    v_pk_add_f32 v[74:75], v[74:75], v[78:79]
    s_waitcnt lgkmcnt(8)
    v_pk_add_f32 v[80:81], v[80:81], v[84:85]
    v_pk_add_f32 v[82:83], v[82:83], v[86:87]
    v_pk_add_f32 v[72:73], v[72:73], v[168:169]
    v_pk_add_f32 v[74:75], v[74:75], v[170:171]
    v_pk_add_f32 v[72:73], v[72:73], v[80:81]
    v_pk_add_f32 v[74:75], v[74:75], v[82:83]
    v_cvt_pk_bf16_f32 v76, v72, v73
    v_cvt_pk_bf16_f32 v77, v74, v75
    buffer_store_dwordx2 v[76:77], v150, s[24:27], s58 offen
    s_waitcnt lgkmcnt(6)
    v_pk_add_f32 v[88:89], v[88:89], v[92:93]
    v_pk_add_f32 v[90:91], v[90:91], v[94:95]
    s_waitcnt lgkmcnt(4)
    v_pk_add_f32 v[96:97], v[96:97], v[100:101]
    v_pk_add_f32 v[98:99], v[98:99], v[102:103]
    v_pk_add_f32 v[88:89], v[88:89], v[172:173]
    v_pk_add_f32 v[90:91], v[90:91], v[174:175]
    v_pk_add_f32 v[88:89], v[88:89], v[96:97]
    v_pk_add_f32 v[90:91], v[90:91], v[98:99]
    v_cvt_pk_bf16_f32 v92, v88, v89
    v_cvt_pk_bf16_f32 v93, v90, v91
    buffer_store_dwordx2 v[92:93], v151, s[24:27], s58 offen
    s_waitcnt lgkmcnt(2)
    v_pk_add_f32 v[104:105], v[104:105], v[108:109]
    v_pk_add_f32 v[106:107], v[106:107], v[110:111]
    s_waitcnt lgkmcnt(0)
    v_pk_add_f32 v[112:113], v[112:113], v[116:117]
    v_pk_add_f32 v[114:115], v[114:115], v[118:119]
    v_pk_add_f32 v[104:105], v[104:105], v[176:177]
    v_pk_add_f32 v[106:107], v[106:107], v[178:179]
    v_pk_add_f32 v[104:105], v[104:105], v[112:113]
    v_pk_add_f32 v[106:107], v[106:107], v[114:115]
    v_cvt_pk_bf16_f32 v108, v104, v105
    v_cvt_pk_bf16_f32 v109, v106, v107
    buffer_store_dwordx2 v[108:109], v152, s[24:27], s58 offen
L_end:
    s_endpgm
L_slow_f1:
    s_mov_b32 s69, 0x8000
L_spin_f1:
    buffer_load_dwordx4 v[248:251], v24, s[28:31], 0 offen sc1
    s_waitcnt vmcnt(0)
    v_xor_b32 v248, s81, v248
    v_xor_b32 v249, s81, v249
    v_xor_b32 v250, s81, v250
    v_xor_b32 v251, s81, v251
    v_or3_b32 v248, v248, v249, v250
    v_or_b32 v248, v248, v251
    v_cmp_ne_u32 vcc, 0, v248
    s_sub_u32 s69, s69, 1
    s_cbranch_scc1 L_ok_f1
    s_cbranch_vccnz L_spin_f1
    s_branch L_ok_f1
L_slow_f2:
    s_mov_b32 s69, 0x8000
L_spin_f2:
    buffer_load_dwordx4 v[248:251], v24, s[28:31], 0 offen sc1
    s_waitcnt vmcnt(0)
    v_xor_b32 v248, s81, v248
    v_xor_b32 v249, s81, v249
    v_xor_b32 v250, s81, v250
    v_xor_b32 v251, s81, v251
    v_or3_b32 v248, v248, v249, v250
    v_or_b32 v248, v248, v251
    v_cmp_ne_u32 vcc, 0, v248
    s_sub_u32 s69, s69, 1
    s_cbranch_scc1 L_ok_f2
    s_cbranch_vccnz L_spin_f2
    s_branch L_ok_f2
L_slow_f3:
    s_mov_b32 s69, 0x8000
L_spin_f3:
    buffer_load_dword v23, v24, s[28:31], 0 offen sc1
    s_waitcnt vmcnt(0)
    v_cmp_ne_u32 vcc, s81, v23
    s_sub_u32 s69, s69, 1
    s_cbranch_scc1 L_ok_f3
    s_cbranch_vccnz L_spin_f3
    s_branch L_ok_f3
L_slow_st:
    s_mov_b32 s69, 0x8000
L_spin_st:
    buffer_load_dwordx4 v[112:115], v126, s[28:31], 0 offen sc1
    buffer_load_dwordx2 v[116:117], v127, s[28:31], 0 offen sc1
    s_waitcnt vmcnt(0)
    v_xor_b32 v118, v27, v113
    v_xor_b32 v119, v27, v115
    v_xor_b32 v117, v27, v117
    v_or3_b32 v118, v118, v119, v117
    v_cmp_ne_u32 vcc, 0, v118
    s_sub_u32 s69, s69, 1
    s_cbranch_scc1 L_ok_st
    s_cbranch_vccnz L_spin_st
    s_branch L_ok_st
L_slow_f4:
    s_mov_b32 s69, 0x8000
L_spin_f4:
    buffer_load_dword v23, v24, s[28:31], 0 offen sc1
    s_waitcnt vmcnt(0)
    v_cmp_ne_u32 vcc, s81, v23
    s_sub_u32 s69, s69, 1
    s_cbranch_scc1 L_ok_f4
    s_cbranch_vccnz L_spin_f4
    s_branch L_ok_f4
L_last:
.section .rodata,"a"
.p2align 6
.amdhsa_kernel parallel_sum__sliding_local_dilated__dense_activation_relu__prompt_kernel
  .amdhsa_next_free_vgpr 512
  .amdhsa_next_free_sgpr 102
  .amdhsa_accum_offset 256
  .amdhsa_group_segment_fixed_size 0
  .amdhsa_kernarg_size 72
  .amdhsa_user_sgpr_count 2
  .amdhsa_user_sgpr_kernarg_segment_ptr 1
  .amdhsa_system_sgpr_workgroup_id_x 1
.end_amdhsa_kernel
```
